```python
import torch

def _softmax(x, axis=-1):
    return torch.softmax(x, dim=axis)

def _gelu(x):
    return torch.nn.functional.gelu(x, approximate='tanh')

def _silu(x):
    return torch.nn.functional.silu(x)

def _sigmoid(x):
    return torch.sigmoid(x)

def _layernorm(x, axis=-1, eps=1e-05):
    m = x.mean(dim=axis, keepdim=True)
    v = x.var(dim=axis, keepdim=True, unbiased=False)
    return (x - m) / torch.sqrt(v + eps)

def _scatter_add(tgt, idx, src, axis=0):
    return tgt.clone().index_add_(axis, idx, src)

def _segment_sum(src, seg, n):
    out = torch.zeros((n,) + src.shape[1:], dtype=src.dtype)
    return out.index_add_(0, seg, src)

def _pad(x, pw):
    flat = tuple((v for pair in reversed(pw) for v in pair))
    return torch.nn.functional.pad(x, flat)
kernel_name = 'standalone__video_videomae__vision'

def setup_inputs():

    _w = lambda a: (lambda t: t.to(torch.bfloat16) if t.is_floating_point() else t)(torch.as_tensor(a))
    T = 4
    N = 384
    C = max(384 // 4 * 4, 8)
    sc = C ** (-0.5)
    return {'x': _w((lambda *s: torch.randn(*s, dtype=torch.bfloat16) * 1.6)(1, T, N, C)), 'w_qkv_t': _w((lambda *s: torch.randn(*s, dtype=torch.bfloat16) * 1.6)(C, 3 * C) * sc), 'w_proj_t': _w((lambda *s: torch.randn(*s, dtype=torch.bfloat16) * 1.6)(C, C) * sc), 'w_qkv_s': _w((lambda *s: torch.randn(*s, dtype=torch.bfloat16) * 1.6)(C, 3 * C) * sc), 'w_proj_s': _w((lambda *s: torch.randn(*s, dtype=torch.bfloat16) * 3.2)(C, C) * sc), 'w1': _w((lambda *s: torch.randn(*s, dtype=torch.bfloat16) * 3.2)(C, 4 * C) * sc), 'w2': _w((lambda *s: torch.randn(*s, dtype=torch.bfloat16) * 0.8)(4 * C, C) * sc)}

def reference(x, w_qkv_t, w_proj_t, w_qkv_s, w_proj_s, w1, w2):
    B, T, N, C = x.shape
    Hd = 4
    D = C // Hd
    scale = D ** (-0.5)
    h = _layernorm(x, axis=-1)
    qkv = torch.einsum('btnc,ce->btne', h, w_qkv_t).reshape(B, T, N, 3, Hd, D)
    q = qkv[:, :, :, 0, :, :].clone()
    k = qkv[:, :, :, 1, :, :].clone()
    v = qkv[:, :, :, 2, :, :].clone()
    a = torch.einsum('btnhd,bsnhd->bnhts', q, k) * scale
    a = _softmax(a, axis=-1)
    o = torch.einsum('bnhts,bsnhd->btnhd', a, v).reshape(B, T, N, C)
    x = x + torch.einsum('btnc,ce->btne', o, w_proj_t)
    h = _layernorm(x, axis=-1)
    qkv = torch.einsum('btnc,ce->btne', h, w_qkv_s).reshape(B, T, N, 3, Hd, D)
    q = qkv[:, :, :, 0, :, :].clone()
    k = qkv[:, :, :, 1, :, :].clone()
    v = qkv[:, :, :, 2, :, :].clone()
    a = torch.einsum('btnhd,btmhd->bthnm', q, k) * scale
    a = _softmax(a, axis=-1)
    o = torch.einsum('bthnm,btmhd->btnhd', a, v).reshape(B, T, N, C)
    x = x + torch.einsum('btnc,ce->btne', o, w_proj_s)
    h = _layernorm(x, axis=-1)
    return x + _gelu(h @ w1) @ w2
```

```asm
; @launch grid=(248,1,1) block=(768,1,1) lds=163840
.amdgcn_target "amdgcn-amd-amdhsa--gfx950"
.text
.globl standalone__video_videomae__vision_kernel
.p2align 8
.type standalone__video_videomae__vision_kernel,@function
standalone__video_videomae__vision_kernel:
    s_cmp_ge_u32 s2, 248
    s_cbranch_scc1 the_end
    s_load_dwordx16 s[48:63], s[0:1], 0
    s_load_dwordx2 s[8:9], s[0:1], 72
    v_lshrrev_b32 v5, 6, v0
    v_and_b32 v1, 63, v0
    v_readfirstlane_b32 s3, v5
    v_and_b32 v2, 15, v0
    v_bfe_u32 v3, v0, 4, 2
    v_lshlrev_b32 v4, 4, v1
    s_mov_b32 s10, 30670848
    s_mov_b32 s11, 0x20000
    s_mov_b32 s40, 0x05040100
    s_mov_b32 s41, 0x07060302
    s_mov_b32 s42, 0xffff0000
    s_cmp_lt_u32 s2, 56
    s_cbranch_scc1 repack
    s_sub_u32 s46, s2, 56
    s_and_b32 s47, s46, 7
    s_lshr_b32 s46, s46, 3
    s_and_b32 s4, s46, 3
    s_lshr_b32 s5, s47, 1
    s_and_b32 s44, s47, 1
    s_and_b32 s4, s46, 1
    s_lshl_b32 s45, s44, 1
    s_add_u32 s4, s4, s45
    s_lshr_b32 s6, s46, 1
    s_lshl_b32 s7, s5, 2
    s_add_u32 s7, s7, s4
    s_mov_b32 s28, s5
    s_lshl_b32 s29, s46, 1
    s_add_u32 s29, s29, s44
    s_mul_i32 s30, s5, 12
    s_add_u32 s30, s30, s6
    s_lshl_b32 s31, s30, 1
    s_mul_i32 s32, s3, 11
    s_lshr_b32 s32, s32, 5
    s_mul_i32 s32, s32, 144
    s_lshl_b32 s45, s3, 4
    s_add_u32 s32, s32, s45
    v_and_b32 v10, 3, v2
    v_mul_u32_u24 v10, 384, v10
    v_lshrrev_b32 v11, 2, v2
    s_lshl_b32 s44, s29, 3
    v_add3_u32 v10, v10, v11, s44
    v_mul_u32_u24 v10, 768, v10
    v_mul_u32_u24 v11, 48, v3
    v_add_u32 v10, v10, v11
    v_mul_u32_u24 v9, 768, v2
    v_add_u32 v9, v9, v11
    s_mul_i32 s33, s31, 12288
    s_add_u32 s33, s33, s32
    s_add_u32 s34, s33, 12288
    s_waitcnt lgkmcnt(0)
    s_add_u32 s46, s8, 29690880
    s_addc_u32 s47, s9, 0
    s_load_dword s43, s[46:47], 0
    s_mov_b32 s12, s48
    s_mov_b32 s13, s49
    s_mov_b32 s14, 1179648
    s_mov_b32 s15, 0x20000
    s_mov_b32 s16, s50
    s_mov_b32 s17, s51
    s_mov_b32 s18, 884736
    s_mov_b32 s19, 0x20000
    s_mov_b32 s20, s52
    s_mov_b32 s21, s53
    s_mov_b32 s22, 294912
    s_mov_b32 s23, 0x20000
    s_mov_b32 s24, s62
    s_mov_b32 s25, s63
    s_mov_b32 s26, 1179648
    s_mov_b32 s27, 0x20000
    buffer_load_dwordx4 v[20:23], v10, s[12:15], s32 offen
    buffer_load_dwordx4 v[24:27], v10, s[12:15], s32 offen offset:3072
    s_lshr_b32 s47, s29, 3
    s_sub_u32 s44, s3, 6
    s_cmp_eq_u32 s44, 3
    s_cbranch_scc1 k1_tx
    s_cmp_ge_u32 s44, 3
    s_cbranch_scc1 k1_nt
    s_lshr_b32 s45, s29, 1
    s_mul_i32 s45, s45, 3
    s_add_u32 s44, s44, s45
    s_lshl_b32 s44, s44, 6
    v_add_u32 v11, s44, v1
    s_cmp_ge_u32 s44, 3456
    s_cbranch_scc1 k1_tp
    v_mul_u32_u24 v10, 21846, v11
    v_lshrrev_b32 v10, 16, v10
    v_mul_u32_u24 v10, 576, v10
    v_lshl_add_u32 v10, v11, 6, v10
    s_mul_i32 s44, s28, 192
    buffer_load_dword v28, v10, s[16:19], s44 offen
    s_branch k1_nt
k1_tx:
    v_min_u32 v10, 47, v1
    v_lshlrev_b32 v10, 7, v10
    s_lshl_b32 s44, s31, 1
    s_add_u32 s44, s44, s4
    s_mul_i32 s44, s44, 6144
    buffer_load_dword v28, v10, s[12:15], s44 offen
    s_branch k1_nt
k1_tp:
    v_lshlrev_b32 v10, 6, v11
    v_subrev_u32 v10, 221184, v10
    s_mul_i32 s44, s28, 73728
    buffer_load_dword v28, v10, s[20:23], s44 offen
k1_nt:
    s_mov_b32 s69, s47
    s_barrier
    s_cmp_ge_u32 s3, 6
    s_cbranch_scc1 k1_proj
    s_mul_i32 s35, s3, 21846
    s_lshr_b32 s35, s35, 16
    s_mul_i32 s36, s35, 3
    s_sub_u32 s36, s3, s36
    v_mul_u32_u24 v68, 55296, v3
    v_mul_u32_u24 v69, 12, v2
    s_mul_i32 s44, s36, 768
    s_mul_i32 s45, s28, 192
    s_add_u32 s44, s44, s45
    s_mul_i32 s45, s35, 442368
    s_add_u32 s44, s44, s45
    v_add3_u32 v68, v68, v69, s44
    v_add_u32 v69, 4608, v68
    v_add_u32 v70, 9216, v68
    v_add_u32 v71, 13824, v68
    s_mov_b32 s44, 0
    buffer_load_dwordx3 v[104:106], v68, s[16:19], s44 offen offset:0
    buffer_load_dwordx3 v[108:110], v68, s[16:19], s44 offen offset:2304
    buffer_load_dwordx3 v[112:114], v69, s[16:19], s44 offen offset:0
    buffer_load_dwordx3 v[116:118], v69, s[16:19], s44 offen offset:2304
    buffer_load_dwordx3 v[120:122], v70, s[16:19], s44 offen offset:0
    buffer_load_dwordx3 v[124:126], v70, s[16:19], s44 offen offset:2304
    buffer_load_dwordx3 v[128:130], v71, s[16:19], s44 offen offset:0
    buffer_load_dwordx3 v[132:134], v71, s[16:19], s44 offen offset:2304
    s_mov_b32 s44, 18432
    buffer_load_dwordx3 v[136:138], v68, s[16:19], s44 offen offset:0
    buffer_load_dwordx3 v[140:142], v68, s[16:19], s44 offen offset:2304
    buffer_load_dwordx3 v[144:146], v69, s[16:19], s44 offen offset:0
    buffer_load_dwordx3 v[148:150], v69, s[16:19], s44 offen offset:2304
    buffer_load_dwordx3 v[152:154], v70, s[16:19], s44 offen offset:0
    buffer_load_dwordx3 v[156:158], v70, s[16:19], s44 offen offset:2304
    buffer_load_dwordx3 v[160:162], v71, s[16:19], s44 offen offset:0
    buffer_load_dwordx3 v[164:166], v71, s[16:19], s44 offen offset:2304
    v_mov_b32 v0, v9
    s_lshl_b32 s44, s3, 10
    v_add_u32 v5, s44, v4
    v_mul_u32_u24 v7, 192, v2
    s_lshl_b32 s44, s3, 4
    v_add_u32 v6, s44, v7
    v_lshrrev_b32 v8, 1, v6
    v_mad_u32_u24 v7, v3, 48, v7
    v_lshrrev_b32 v9, 1, v7
    s_lshl_b32 s44, s3, 2
    v_add_u32 v6, s44, v7
    v_lshrrev_b32 v11, 2, v2
    v_cmp_eq_u32 vcc, 0, v11
    s_nop 1
    v_cndmask_b32_e64 v60, 0, 1.0, vcc
    v_cmp_eq_u32 vcc, 1, v11
    s_nop 1
    v_cndmask_b32_e64 v61, 0, 1.0, vcc
    v_cmp_eq_u32 vcc, 2, v11
    s_nop 1
    v_cndmask_b32_e64 v62, 0, 1.0, vcc
    v_cmp_eq_u32 vcc, 3, v11
    s_nop 1
    v_cndmask_b32_e64 v63, 0, 1.0, vcc
    s_waitcnt vmcnt(17)
    v_lshlrev_b32 v28, 16, v20
    v_and_b32 v32, s42, v20
    v_lshlrev_b32 v29, 16, v21
    v_and_b32 v33, s42, v21
    v_lshlrev_b32 v30, 16, v22
    v_and_b32 v34, s42, v22
    v_lshlrev_b32 v31, 16, v23
    v_and_b32 v35, s42, v23
    s_waitcnt vmcnt(16)
    v_lshlrev_b32 v36, 16, v24
    v_and_b32 v40, s42, v24
    v_lshlrev_b32 v37, 16, v25
    v_and_b32 v41, s42, v25
    v_lshlrev_b32 v38, 16, v26
    v_and_b32 v42, s42, v26
    v_lshlrev_b32 v39, 16, v27
    v_and_b32 v43, s42, v27
    v_pk_add_f32 v[44:45], v[28:29], v[30:31]
    v_pk_mul_f32 v[46:47], v[28:29], v[28:29]
    v_pk_add_f32 v[44:45], v[44:45], v[32:33]
    v_pk_fma_f32 v[46:47], v[30:31], v[30:31], v[46:47]
    v_pk_add_f32 v[44:45], v[44:45], v[34:35]
    v_pk_fma_f32 v[46:47], v[32:33], v[32:33], v[46:47]
    v_pk_fma_f32 v[46:47], v[34:35], v[34:35], v[46:47]
    v_add_f32 v56, v44, v45
    v_add_f32 v57, v46, v47
    v_pk_add_f32 v[44:45], v[36:37], v[38:39]
    v_pk_mul_f32 v[46:47], v[36:37], v[36:37]
    v_pk_add_f32 v[44:45], v[44:45], v[40:41]
    v_pk_fma_f32 v[46:47], v[38:39], v[38:39], v[46:47]
    v_pk_add_f32 v[44:45], v[44:45], v[42:43]
    v_pk_fma_f32 v[46:47], v[40:41], v[40:41], v[46:47]
    v_pk_fma_f32 v[46:47], v[42:43], v[42:43], v[46:47]
    v_add_f32 v58, v44, v45
    v_add_f32 v59, v46, v47
    v_mfma_f32_16x16x4_f32 v[48:51], v60, v56, 0
    v_mfma_f32_16x16x4_f32 v[48:51], v61, v57, v[48:51]
    v_mfma_f32_16x16x4_f32 v[48:51], v62, v58, v[48:51]
    v_mfma_f32_16x16x4_f32 v[48:51], v63, v59, v[48:51]
    v_and_b32 v10, 3, v2
    v_cmp_eq_u32 vcc, v10, v3
    s_nop 1
    v_cndmask_b32_e64 v10, 0, 1.0, vcc
    s_nop 6
    ds_write_b32 v6, v48 offset:24576
    s_waitcnt lgkmcnt(0)
    s_barrier
    ds_read_b128 v[44:47], v7 offset:24576
    ds_read_b128 v[48:51], v7 offset:24592
    ds_read_b128 v[52:55], v7 offset:24608
    s_waitcnt vmcnt(8)
    v_perm_b32 v72, v108, v104, s40
    v_perm_b32 v73, v116, v112, s40
    v_perm_b32 v74, v124, v120, s40
    v_perm_b32 v75, v132, v128, s40
    v_perm_b32 v76, v108, v104, s41
    v_perm_b32 v77, v116, v112, s41
    v_perm_b32 v78, v124, v120, s41
    v_perm_b32 v79, v132, v128, s41
    v_perm_b32 v80, v109, v105, s40
    v_perm_b32 v81, v117, v113, s40
    v_perm_b32 v82, v125, v121, s40
    v_perm_b32 v83, v133, v129, s40
    v_perm_b32 v84, v109, v105, s41
    v_perm_b32 v85, v117, v113, s41
    v_perm_b32 v86, v125, v121, s41
    v_perm_b32 v87, v133, v129, s41
    v_perm_b32 v88, v110, v106, s40
    v_perm_b32 v89, v118, v114, s40
    v_perm_b32 v90, v126, v122, s40
    v_perm_b32 v91, v134, v130, s40
    v_perm_b32 v92, v110, v106, s41
    v_perm_b32 v93, v118, v114, s41
    v_perm_b32 v94, v126, v122, s41
    v_perm_b32 v95, v134, v130, s41
    s_mov_b32 s44, 36864
    buffer_load_dwordx3 v[104:106], v68, s[16:19], s44 offen offset:0
    buffer_load_dwordx3 v[108:110], v68, s[16:19], s44 offen offset:2304
    buffer_load_dwordx3 v[112:114], v69, s[16:19], s44 offen offset:0
    buffer_load_dwordx3 v[116:118], v69, s[16:19], s44 offen offset:2304
    buffer_load_dwordx3 v[120:122], v70, s[16:19], s44 offen offset:0
    buffer_load_dwordx3 v[124:126], v70, s[16:19], s44 offen offset:2304
    buffer_load_dwordx3 v[128:130], v71, s[16:19], s44 offen offset:0
    buffer_load_dwordx3 v[132:134], v71, s[16:19], s44 offen offset:2304
    s_waitcnt lgkmcnt(0)
    v_pk_add_f32 v[44:45], v[44:45], v[48:49]
    v_pk_add_f32 v[46:47], v[46:47], v[50:51]
    v_pk_add_f32 v[44:45], v[44:45], v[52:53]
    v_pk_add_f32 v[46:47], v[46:47], v[54:55]
    v_pk_add_f32 v[44:45], v[44:45], v[46:47]
    v_add_f32 v44, v44, v45
    s_nop 1
    v_mfma_f32_16x16x4_f32 v[56:59], v10, v44, 0
    s_nop 11
    v_mul_f32 v56, 0x3b2aaaab, v56
    v_mul_f32 v57, 0x3b2aaaab, v57
    v_fma_f32 v57, -v56, v56, v57
    v_max_f32 v57, 0, v57
    v_add_f32 v57, 0x3727c5ac, v57
    v_rsq_f32 v57, v57
    s_nop 0
    v_mul_f32 v56, -v56, v57
    v_mul_f32 v58, 0x3b2aaaab, v58
    v_mul_f32 v59, 0x3b2aaaab, v59
    v_fma_f32 v59, -v58, v58, v59
    v_max_f32 v59, 0, v59
    v_add_f32 v59, 0x3727c5ac, v59
    v_rsq_f32 v59, v59
    s_nop 0
    v_mul_f32 v58, -v58, v59
    v_pk_fma_f32 v[28:29], v[28:29], v[56:57], v[56:57] op_sel:[0,1,0] op_sel_hi:[1,1,0]
    v_pk_fma_f32 v[30:31], v[30:31], v[56:57], v[56:57] op_sel:[0,1,0] op_sel_hi:[1,1,0]
    v_pk_fma_f32 v[32:33], v[32:33], v[56:57], v[56:57] op_sel:[0,1,0] op_sel_hi:[1,1,0]
    v_pk_fma_f32 v[34:35], v[34:35], v[56:57], v[56:57] op_sel:[0,1,0] op_sel_hi:[1,1,0]
    v_cvt_pk_bf16_f32 v44, v28, v32
    v_cvt_pk_bf16_f32 v45, v29, v33
    v_cvt_pk_bf16_f32 v46, v30, v34
    v_cvt_pk_bf16_f32 v47, v31, v35
    ds_write_b128 v5, v[44:47] offset:0
    v_pk_fma_f32 v[36:37], v[36:37], v[58:59], v[58:59] op_sel:[0,1,0] op_sel_hi:[1,1,0]
    v_pk_fma_f32 v[38:39], v[38:39], v[58:59], v[58:59] op_sel:[0,1,0] op_sel_hi:[1,1,0]
    v_pk_fma_f32 v[40:41], v[40:41], v[58:59], v[58:59] op_sel:[0,1,0] op_sel_hi:[1,1,0]
    v_pk_fma_f32 v[42:43], v[42:43], v[58:59], v[58:59] op_sel:[0,1,0] op_sel_hi:[1,1,0]
    v_cvt_pk_bf16_f32 v48, v36, v40
    v_cvt_pk_bf16_f32 v49, v37, v41
    v_cvt_pk_bf16_f32 v50, v38, v42
    v_cvt_pk_bf16_f32 v51, v39, v43
    ds_write_b128 v5, v[48:51] offset:12288
    s_waitcnt lgkmcnt(0)
    s_barrier
    s_add_u32 s43, s43, 1
    s_mov_b32 s100, s43
    s_mov_b32 s101, s43
    s_mul_i32 s44, s35, 18432
    v_add_u32 v10, s44, v4
    s_mul_i32 s44, s35, 6144
    s_sub_u32 s44, 12288, s44
    v_add_u32 v11, s44, v4
    s_cmp_eq_u32 s36, 2
    s_cbranch_scc1 k1_v
    ds_read_b128 v[96:99], v10 offset:0
    ds_read_b128 v[100:103], v11 offset:0
    s_waitcnt lgkmcnt(0)
    v_mfma_f32_16x16x32_bf16 v[20:23], v[72:75], v[96:99], 0
    v_mfma_f32_16x16x32_bf16 v[24:27], v[72:75], v[100:103], 0
    v_mfma_f32_16x16x32_bf16 v[28:31], v[76:79], v[96:99], 0
    v_mfma_f32_16x16x32_bf16 v[32:35], v[76:79], v[100:103], 0
    v_mfma_f32_16x16x32_bf16 v[36:39], v[80:83], v[96:99], 0
    v_mfma_f32_16x16x32_bf16 v[40:43], v[80:83], v[100:103], 0
    v_mfma_f32_16x16x32_bf16 v[44:47], v[84:87], v[96:99], 0
    v_mfma_f32_16x16x32_bf16 v[48:51], v[84:87], v[100:103], 0
    v_mfma_f32_16x16x32_bf16 v[52:55], v[88:91], v[96:99], 0
    v_mfma_f32_16x16x32_bf16 v[56:59], v[88:91], v[100:103], 0
    v_mfma_f32_16x16x32_bf16 v[60:63], v[92:95], v[96:99], 0
    v_mfma_f32_16x16x32_bf16 v[64:67], v[92:95], v[100:103], 0
    ds_read_b128 v[96:99], v10 offset:1024
    ds_read_b128 v[100:103], v11 offset:1024
    s_waitcnt vmcnt(8)
    v_perm_b32 v72, v140, v136, s40
    v_perm_b32 v73, v148, v144, s40
    v_perm_b32 v74, v156, v152, s40
    v_perm_b32 v75, v164, v160, s40
    v_perm_b32 v76, v140, v136, s41
    v_perm_b32 v77, v148, v144, s41
    v_perm_b32 v78, v156, v152, s41
    v_perm_b32 v79, v164, v160, s41
    v_perm_b32 v80, v141, v137, s40
    v_perm_b32 v81, v149, v145, s40
    v_perm_b32 v82, v157, v153, s40
    v_perm_b32 v83, v165, v161, s40
    v_perm_b32 v84, v141, v137, s41
    v_perm_b32 v85, v149, v145, s41
    v_perm_b32 v86, v157, v153, s41
    v_perm_b32 v87, v165, v161, s41
    v_perm_b32 v88, v142, v138, s40
    v_perm_b32 v89, v150, v146, s40
    v_perm_b32 v90, v158, v154, s40
    v_perm_b32 v91, v166, v162, s40
    v_perm_b32 v92, v142, v138, s41
    v_perm_b32 v93, v150, v146, s41
    v_perm_b32 v94, v158, v154, s41
    v_perm_b32 v95, v166, v162, s41
    s_mov_b32 s44, 221184
    buffer_load_dwordx3 v[136:138], v68, s[16:19], s44 offen offset:0
    buffer_load_dwordx3 v[140:142], v68, s[16:19], s44 offen offset:2304
    buffer_load_dwordx3 v[144:146], v69, s[16:19], s44 offen offset:0
    buffer_load_dwordx3 v[148:150], v69, s[16:19], s44 offen offset:2304
    buffer_load_dwordx3 v[152:154], v70, s[16:19], s44 offen offset:0
    buffer_load_dwordx3 v[156:158], v70, s[16:19], s44 offen offset:2304
    buffer_load_dwordx3 v[160:162], v71, s[16:19], s44 offen offset:0
    buffer_load_dwordx3 v[164:166], v71, s[16:19], s44 offen offset:2304
    s_waitcnt lgkmcnt(0)
    v_mfma_f32_16x16x32_bf16 v[20:23], v[72:75], v[96:99], v[20:23]
    v_mfma_f32_16x16x32_bf16 v[24:27], v[72:75], v[100:103], v[24:27]
    v_mfma_f32_16x16x32_bf16 v[28:31], v[76:79], v[96:99], v[28:31]
    v_mfma_f32_16x16x32_bf16 v[32:35], v[76:79], v[100:103], v[32:35]
    v_mfma_f32_16x16x32_bf16 v[36:39], v[80:83], v[96:99], v[36:39]
    v_mfma_f32_16x16x32_bf16 v[40:43], v[80:83], v[100:103], v[40:43]
    v_mfma_f32_16x16x32_bf16 v[44:47], v[84:87], v[96:99], v[44:47]
    v_mfma_f32_16x16x32_bf16 v[48:51], v[84:87], v[100:103], v[48:51]
    v_mfma_f32_16x16x32_bf16 v[52:55], v[88:91], v[96:99], v[52:55]
    v_mfma_f32_16x16x32_bf16 v[56:59], v[88:91], v[100:103], v[56:59]
    v_mfma_f32_16x16x32_bf16 v[60:63], v[92:95], v[96:99], v[60:63]
    v_mfma_f32_16x16x32_bf16 v[64:67], v[92:95], v[100:103], v[64:67]
    ds_read_b128 v[96:99], v10 offset:2048
    ds_read_b128 v[100:103], v11 offset:2048
    s_waitcnt vmcnt(8)
    v_perm_b32 v72, v108, v104, s40
    v_perm_b32 v73, v116, v112, s40
    v_perm_b32 v74, v124, v120, s40
    v_perm_b32 v75, v132, v128, s40
    v_perm_b32 v76, v108, v104, s41
    v_perm_b32 v77, v116, v112, s41
    v_perm_b32 v78, v124, v120, s41
    v_perm_b32 v79, v132, v128, s41
    v_perm_b32 v80, v109, v105, s40
    v_perm_b32 v81, v117, v113, s40
    v_perm_b32 v82, v125, v121, s40
    v_perm_b32 v83, v133, v129, s40
    v_perm_b32 v84, v109, v105, s41
    v_perm_b32 v85, v117, v113, s41
    v_perm_b32 v86, v125, v121, s41
    v_perm_b32 v87, v133, v129, s41
    v_perm_b32 v88, v110, v106, s40
    v_perm_b32 v89, v118, v114, s40
    v_perm_b32 v90, v126, v122, s40
    v_perm_b32 v91, v134, v130, s40
    v_perm_b32 v92, v110, v106, s41
    v_perm_b32 v93, v118, v114, s41
    v_perm_b32 v94, v126, v122, s41
    v_perm_b32 v95, v134, v130, s41
    s_mov_b32 s44, 239616
    buffer_load_dwordx3 v[104:106], v68, s[16:19], s44 offen offset:0
    buffer_load_dwordx3 v[108:110], v68, s[16:19], s44 offen offset:2304
    buffer_load_dwordx3 v[112:114], v69, s[16:19], s44 offen offset:0
    buffer_load_dwordx3 v[116:118], v69, s[16:19], s44 offen offset:2304
    buffer_load_dwordx3 v[120:122], v70, s[16:19], s44 offen offset:0
    buffer_load_dwordx3 v[124:126], v70, s[16:19], s44 offen offset:2304
    buffer_load_dwordx3 v[128:130], v71, s[16:19], s44 offen offset:0
    buffer_load_dwordx3 v[132:134], v71, s[16:19], s44 offen offset:2304
    s_waitcnt lgkmcnt(0)
    v_mfma_f32_16x16x32_bf16 v[20:23], v[72:75], v[96:99], v[20:23]
    v_mfma_f32_16x16x32_bf16 v[24:27], v[72:75], v[100:103], v[24:27]
    v_mfma_f32_16x16x32_bf16 v[28:31], v[76:79], v[96:99], v[28:31]
    v_mfma_f32_16x16x32_bf16 v[32:35], v[76:79], v[100:103], v[32:35]
    v_mfma_f32_16x16x32_bf16 v[36:39], v[80:83], v[96:99], v[36:39]
    v_mfma_f32_16x16x32_bf16 v[40:43], v[80:83], v[100:103], v[40:43]
    v_mfma_f32_16x16x32_bf16 v[44:47], v[84:87], v[96:99], v[44:47]
    v_mfma_f32_16x16x32_bf16 v[48:51], v[84:87], v[100:103], v[48:51]
    v_mfma_f32_16x16x32_bf16 v[52:55], v[88:91], v[96:99], v[52:55]
    v_mfma_f32_16x16x32_bf16 v[56:59], v[88:91], v[100:103], v[56:59]
    v_mfma_f32_16x16x32_bf16 v[60:63], v[92:95], v[96:99], v[60:63]
    v_mfma_f32_16x16x32_bf16 v[64:67], v[92:95], v[100:103], v[64:67]
    ds_read_b128 v[96:99], v10 offset:3072
    ds_read_b128 v[100:103], v11 offset:3072
    s_waitcnt vmcnt(8)
    v_perm_b32 v72, v140, v136, s40
    v_perm_b32 v73, v148, v144, s40
    v_perm_b32 v74, v156, v152, s40
    v_perm_b32 v75, v164, v160, s40
    v_perm_b32 v76, v140, v136, s41
    v_perm_b32 v77, v148, v144, s41
    v_perm_b32 v78, v156, v152, s41
    v_perm_b32 v79, v164, v160, s41
    v_perm_b32 v80, v141, v137, s40
    v_perm_b32 v81, v149, v145, s40
    v_perm_b32 v82, v157, v153, s40
    v_perm_b32 v83, v165, v161, s40
    v_perm_b32 v84, v141, v137, s41
    v_perm_b32 v85, v149, v145, s41
    v_perm_b32 v86, v157, v153, s41
    v_perm_b32 v87, v165, v161, s41
    v_perm_b32 v88, v142, v138, s40
    v_perm_b32 v89, v150, v146, s40
    v_perm_b32 v90, v158, v154, s40
    v_perm_b32 v91, v166, v162, s40
    v_perm_b32 v92, v142, v138, s41
    v_perm_b32 v93, v150, v146, s41
    v_perm_b32 v94, v158, v154, s41
    v_perm_b32 v95, v166, v162, s41
    s_mov_b32 s44, 258048
    buffer_load_dwordx3 v[136:138], v68, s[16:19], s44 offen offset:0
    buffer_load_dwordx3 v[140:142], v68, s[16:19], s44 offen offset:2304
    buffer_load_dwordx3 v[144:146], v69, s[16:19], s44 offen offset:0
    buffer_load_dwordx3 v[148:150], v69, s[16:19], s44 offen offset:2304
    buffer_load_dwordx3 v[152:154], v70, s[16:19], s44 offen offset:0
    buffer_load_dwordx3 v[156:158], v70, s[16:19], s44 offen offset:2304
    buffer_load_dwordx3 v[160:162], v71, s[16:19], s44 offen offset:0
    buffer_load_dwordx3 v[164:166], v71, s[16:19], s44 offen offset:2304
    s_waitcnt lgkmcnt(0)
    v_mfma_f32_16x16x32_bf16 v[20:23], v[72:75], v[96:99], v[20:23]
    v_mfma_f32_16x16x32_bf16 v[24:27], v[72:75], v[100:103], v[24:27]
    v_mfma_f32_16x16x32_bf16 v[28:31], v[76:79], v[96:99], v[28:31]
    v_mfma_f32_16x16x32_bf16 v[32:35], v[76:79], v[100:103], v[32:35]
    v_mfma_f32_16x16x32_bf16 v[36:39], v[80:83], v[96:99], v[36:39]
    v_mfma_f32_16x16x32_bf16 v[40:43], v[80:83], v[100:103], v[40:43]
    v_mfma_f32_16x16x32_bf16 v[44:47], v[84:87], v[96:99], v[44:47]
    v_mfma_f32_16x16x32_bf16 v[48:51], v[84:87], v[100:103], v[48:51]
    v_mfma_f32_16x16x32_bf16 v[52:55], v[88:91], v[96:99], v[52:55]
    v_mfma_f32_16x16x32_bf16 v[56:59], v[88:91], v[100:103], v[56:59]
    v_mfma_f32_16x16x32_bf16 v[60:63], v[92:95], v[96:99], v[60:63]
    v_mfma_f32_16x16x32_bf16 v[64:67], v[92:95], v[100:103], v[64:67]
    ds_read_b128 v[96:99], v10 offset:4096
    ds_read_b128 v[100:103], v11 offset:4096
    s_waitcnt vmcnt(8)
    v_perm_b32 v72, v108, v104, s40
    v_perm_b32 v73, v116, v112, s40
    v_perm_b32 v74, v124, v120, s40
    v_perm_b32 v75, v132, v128, s40
    v_perm_b32 v76, v108, v104, s41
    v_perm_b32 v77, v116, v112, s41
    v_perm_b32 v78, v124, v120, s41
    v_perm_b32 v79, v132, v128, s41
    v_perm_b32 v80, v109, v105, s40
    v_perm_b32 v81, v117, v113, s40
    v_perm_b32 v82, v125, v121, s40
    v_perm_b32 v83, v133, v129, s40
    v_perm_b32 v84, v109, v105, s41
    v_perm_b32 v85, v117, v113, s41
    v_perm_b32 v86, v125, v121, s41
    v_perm_b32 v87, v133, v129, s41
    v_perm_b32 v88, v110, v106, s40
    v_perm_b32 v89, v118, v114, s40
    v_perm_b32 v90, v126, v122, s40
    v_perm_b32 v91, v134, v130, s40
    v_perm_b32 v92, v110, v106, s41
    v_perm_b32 v93, v118, v114, s41
    v_perm_b32 v94, v126, v122, s41
    v_perm_b32 v95, v134, v130, s41
    s_waitcnt lgkmcnt(0)
    v_mfma_f32_16x16x32_bf16 v[20:23], v[72:75], v[96:99], v[20:23]
    v_mfma_f32_16x16x32_bf16 v[24:27], v[72:75], v[100:103], v[24:27]
    v_mfma_f32_16x16x32_bf16 v[28:31], v[76:79], v[96:99], v[28:31]
    v_mfma_f32_16x16x32_bf16 v[32:35], v[76:79], v[100:103], v[32:35]
    v_mfma_f32_16x16x32_bf16 v[36:39], v[80:83], v[96:99], v[36:39]
    v_mfma_f32_16x16x32_bf16 v[40:43], v[80:83], v[100:103], v[40:43]
    v_mfma_f32_16x16x32_bf16 v[44:47], v[84:87], v[96:99], v[44:47]
    v_mfma_f32_16x16x32_bf16 v[48:51], v[84:87], v[100:103], v[48:51]
    v_mfma_f32_16x16x32_bf16 v[52:55], v[88:91], v[96:99], v[52:55]
    v_mfma_f32_16x16x32_bf16 v[56:59], v[88:91], v[100:103], v[56:59]
    v_mfma_f32_16x16x32_bf16 v[60:63], v[92:95], v[96:99], v[60:63]
    v_mfma_f32_16x16x32_bf16 v[64:67], v[92:95], v[100:103], v[64:67]
    ds_read_b128 v[96:99], v10 offset:5120
    ds_read_b128 v[100:103], v11 offset:5120
    s_waitcnt vmcnt(0)
    v_perm_b32 v72, v140, v136, s40
    v_perm_b32 v73, v148, v144, s40
    v_perm_b32 v74, v156, v152, s40
    v_perm_b32 v75, v164, v160, s40
    v_perm_b32 v76, v140, v136, s41
    v_perm_b32 v77, v148, v144, s41
    v_perm_b32 v78, v156, v152, s41
    v_perm_b32 v79, v164, v160, s41
    v_perm_b32 v80, v141, v137, s40
    v_perm_b32 v81, v149, v145, s40
    v_perm_b32 v82, v157, v153, s40
    v_perm_b32 v83, v165, v161, s40
    v_perm_b32 v84, v141, v137, s41
    v_perm_b32 v85, v149, v145, s41
    v_perm_b32 v86, v157, v153, s41
    v_perm_b32 v87, v165, v161, s41
    v_perm_b32 v88, v142, v138, s40
    v_perm_b32 v89, v150, v146, s40
    v_perm_b32 v90, v158, v154, s40
    v_perm_b32 v91, v166, v162, s40
    v_perm_b32 v92, v142, v138, s41
    v_perm_b32 v93, v150, v146, s41
    v_perm_b32 v94, v158, v154, s41
    v_perm_b32 v95, v166, v162, s41
    s_waitcnt lgkmcnt(0)
    v_mfma_f32_16x16x32_bf16 v[20:23], v[72:75], v[96:99], v[20:23]
    v_mfma_f32_16x16x32_bf16 v[24:27], v[72:75], v[100:103], v[24:27]
    v_mfma_f32_16x16x32_bf16 v[28:31], v[76:79], v[96:99], v[28:31]
    v_mfma_f32_16x16x32_bf16 v[32:35], v[76:79], v[100:103], v[32:35]
    v_mfma_f32_16x16x32_bf16 v[36:39], v[80:83], v[96:99], v[36:39]
    v_mfma_f32_16x16x32_bf16 v[40:43], v[80:83], v[100:103], v[40:43]
    v_mfma_f32_16x16x32_bf16 v[44:47], v[84:87], v[96:99], v[44:47]
    v_mfma_f32_16x16x32_bf16 v[48:51], v[84:87], v[100:103], v[48:51]
    v_mfma_f32_16x16x32_bf16 v[52:55], v[88:91], v[96:99], v[52:55]
    v_mfma_f32_16x16x32_bf16 v[56:59], v[88:91], v[100:103], v[56:59]
    v_mfma_f32_16x16x32_bf16 v[60:63], v[92:95], v[96:99], v[60:63]
    v_mfma_f32_16x16x32_bf16 v[64:67], v[92:95], v[100:103], v[64:67]
    s_lshl_b32 s44, s36, 1
    s_add_u32 s44, s44, s35
    s_mul_i32 s46, s44, 3072
    s_mul_i32 s45, s44, 6144
    s_add_u32 s45, s45, 65536
    v_add_u32 v10, s45, v4
    s_xor_b32 s44, s44, 1
    s_mul_i32 s45, s44, 6144
    s_add_u32 s45, s45, 65536
    v_add_u32 v11, s45, v4
    ds_write_b128 v11, v[24:27] offset:0
    ds_write_b128 v11, v[32:35] offset:1024
    ds_write_b128 v11, v[40:43] offset:2048
    ds_write_b128 v11, v[48:51] offset:3072
    ds_write_b128 v11, v[56:59] offset:4096
    ds_write_b128 v11, v[64:67] offset:5120
    s_waitcnt lgkmcnt(0)
    s_barrier
    ds_read_b128 v[24:27], v10 offset:0
    ds_read_b128 v[32:35], v10 offset:1024
    ds_read_b128 v[40:43], v10 offset:2048
    ds_read_b128 v[48:51], v10 offset:3072
    ds_read_b128 v[56:59], v10 offset:4096
    ds_read_b128 v[64:67], v10 offset:5120
    v_add_u32 v10, s46, v4
    s_waitcnt lgkmcnt(5)
    v_pk_add_f32 v[20:21], v[20:21], v[24:25]
    v_pk_add_f32 v[22:23], v[22:23], v[26:27]
    s_waitcnt lgkmcnt(4)
    v_pk_add_f32 v[28:29], v[28:29], v[32:33]
    v_pk_add_f32 v[30:31], v[30:31], v[34:35]
    s_waitcnt lgkmcnt(3)
    v_pk_add_f32 v[36:37], v[36:37], v[40:41]
    v_pk_add_f32 v[38:39], v[38:39], v[42:43]
    s_waitcnt lgkmcnt(2)
    v_pk_add_f32 v[44:45], v[44:45], v[48:49]
    v_pk_add_f32 v[46:47], v[46:47], v[50:51]
    s_waitcnt lgkmcnt(1)
    v_pk_add_f32 v[52:53], v[52:53], v[56:57]
    v_pk_add_f32 v[54:55], v[54:55], v[58:59]
    s_waitcnt lgkmcnt(0)
    v_pk_add_f32 v[60:61], v[60:61], v[64:65]
    v_pk_add_f32 v[62:63], v[62:63], v[66:67]
    v_cvt_pk_bf16_f32 v72, v20, v28
    v_cvt_pk_bf16_f32 v73, v36, v44
    v_cvt_pk_bf16_f32 v74, v52, v60
    v_cvt_pk_bf16_f32 v75, v21, v29
    v_cvt_pk_bf16_f32 v76, v37, v45
    v_cvt_pk_bf16_f32 v77, v53, v61
    v_cvt_pk_bf16_f32 v78, v22, v30
    v_cvt_pk_bf16_f32 v79, v38, v46
    v_cvt_pk_bf16_f32 v80, v54, v62
    v_cvt_pk_bf16_f32 v81, v23, v31
    v_cvt_pk_bf16_f32 v82, v39, v47
    v_cvt_pk_bf16_f32 v83, v55, v63
    ds_write_b128 v10, v[72:75] offset:0
    ds_write_b128 v10, v[76:79] offset:1024
    ds_write_b128 v10, v[80:83] offset:2048
    s_waitcnt lgkmcnt(0)
    s_barrier
    s_lshl_b32 s38, s35, 2
    s_add_u32 s38, s38, s4
    s_lshl_b32 s38, s38, 7
    s_add_u32 s38, s38, 29684736
    s_mov_b32 s45, 65536
L1:
    s_load_dwordx8 s[48:55], s[8:9], s38 offset:0
    s_load_dwordx4 s[56:59], s[8:9], s38 offset:32
    s_waitcnt lgkmcnt(0)
    s_xor_b64 s[48:49], s[48:49], s[100:101]
    s_xor_b64 s[50:51], s[50:51], s[100:101]
    s_xor_b64 s[52:53], s[52:53], s[100:101]
    s_xor_b64 s[54:55], s[54:55], s[100:101]
    s_xor_b64 s[56:57], s[56:57], s[100:101]
    s_xor_b64 s[58:59], s[58:59], s[100:101]
    s_or_b64 s[48:49], s[48:49], s[50:51]
    s_or_b64 s[48:49], s[48:49], s[52:53]
    s_or_b64 s[48:49], s[48:49], s[54:55]
    s_or_b64 s[48:49], s[48:49], s[56:57]
    s_or_b64 s[48:49], s[48:49], s[58:59]
    s_cbranch_scc0 L2
    v_min_u32 v10, 11, v2
    v_lshl_add_u32 v10, v10, 2, s38
    s_mov_b32 s45, 32768
L3:
    buffer_load_dword v11, v10, s[8:11], 0 offen sc1
    s_waitcnt vmcnt(0)
    v_cmp_ne_u32 vcc, s43, v11
    s_nop 1
    s_cbranch_vccz L4
    s_sub_u32 s45, s45, 1
    s_cbranch_scc1 L4
    s_sleep 1
    s_branch L3
L4:
L2:
    s_mul_i32 s46, s4, 6
    s_add_u32 s46, s46, s3
    s_mul_i32 s46, s46, 24576
    s_add_u32 s46, s46, 24772608
    s_add_u32 s44, s46, 0
    buffer_load_dwordx4 v[72:75], v4, s[8:11], s44 offen offset:0 sc1
    buffer_load_dwordx4 v[76:79], v4, s[8:11], s44 offen offset:1024 sc1
    buffer_load_dwordx4 v[80:83], v4, s[8:11], s44 offen offset:2048 sc1
    buffer_load_dwordx4 v[84:87], v4, s[8:11], s44 offen offset:3072 sc1
    s_add_u32 s44, s46, 4096
    buffer_load_dwordx4 v[88:91], v4, s[8:11], s44 offen offset:0 sc1
    buffer_load_dwordx4 v[92:95], v4, s[8:11], s44 offen offset:1024 sc1
    buffer_load_dwordx4 v[96:99], v4, s[8:11], s44 offen offset:2048 sc1
    buffer_load_dwordx4 v[100:103], v4, s[8:11], s44 offen offset:3072 sc1
    s_add_u32 s44, s46, 8192
    buffer_load_dwordx4 v[104:107], v4, s[8:11], s44 offen offset:0 sc1
    buffer_load_dwordx4 v[108:111], v4, s[8:11], s44 offen offset:1024 sc1
    buffer_load_dwordx4 v[112:115], v4, s[8:11], s44 offen offset:2048 sc1
    buffer_load_dwordx4 v[116:119], v4, s[8:11], s44 offen offset:3072 sc1
    s_barrier
    s_barrier
    s_add_u32 s44, s46, 12288
    buffer_load_dwordx4 v[120:123], v4, s[8:11], s44 offen offset:0 sc1
    buffer_load_dwordx4 v[124:127], v4, s[8:11], s44 offen offset:1024 sc1
    buffer_load_dwordx4 v[128:131], v4, s[8:11], s44 offen offset:2048 sc1
    buffer_load_dwordx4 v[132:135], v4, s[8:11], s44 offen offset:3072 sc1
    s_add_u32 s44, s46, 16384
    buffer_load_dwordx4 v[136:139], v4, s[8:11], s44 offen offset:0 sc1
    buffer_load_dwordx4 v[140:143], v4, s[8:11], s44 offen offset:1024 sc1
    buffer_load_dwordx4 v[144:147], v4, s[8:11], s44 offen offset:2048 sc1
    buffer_load_dwordx4 v[148:151], v4, s[8:11], s44 offen offset:3072 sc1
    s_add_u32 s44, s46, 20480
    buffer_load_dwordx4 v[152:155], v4, s[8:11], s44 offen offset:0 sc1
    buffer_load_dwordx4 v[156:159], v4, s[8:11], s44 offen offset:1024 sc1
    buffer_load_dwordx4 v[160:163], v4, s[8:11], s44 offen offset:2048 sc1
    buffer_load_dwordx4 v[164:167], v4, s[8:11], s44 offen offset:3072 sc1
    s_branch k2
k1_v:
    ds_read_b128 v[96:99], v10 offset:0
    ds_read_b128 v[100:103], v11 offset:0
    s_waitcnt lgkmcnt(0)
    v_mfma_f32_16x16x32_bf16 v[20:23], v[96:99], v[72:75], 0
    v_mfma_f32_16x16x32_bf16 v[24:27], v[100:103], v[72:75], 0
    v_mfma_f32_16x16x32_bf16 v[28:31], v[96:99], v[76:79], 0
    v_mfma_f32_16x16x32_bf16 v[32:35], v[100:103], v[76:79], 0
    v_mfma_f32_16x16x32_bf16 v[36:39], v[96:99], v[80:83], 0
    v_mfma_f32_16x16x32_bf16 v[40:43], v[100:103], v[80:83], 0
    v_mfma_f32_16x16x32_bf16 v[44:47], v[96:99], v[84:87], 0
    v_mfma_f32_16x16x32_bf16 v[48:51], v[100:103], v[84:87], 0
    v_mfma_f32_16x16x32_bf16 v[52:55], v[96:99], v[88:91], 0
    v_mfma_f32_16x16x32_bf16 v[56:59], v[100:103], v[88:91], 0
    v_mfma_f32_16x16x32_bf16 v[60:63], v[96:99], v[92:95], 0
    v_mfma_f32_16x16x32_bf16 v[64:67], v[100:103], v[92:95], 0
    ds_read_b128 v[96:99], v10 offset:1024
    ds_read_b128 v[100:103], v11 offset:1024
    s_waitcnt vmcnt(8)
    v_perm_b32 v72, v140, v136, s40
    v_perm_b32 v73, v148, v144, s40
    v_perm_b32 v74, v156, v152, s40
    v_perm_b32 v75, v164, v160, s40
    v_perm_b32 v76, v140, v136, s41
    v_perm_b32 v77, v148, v144, s41
    v_perm_b32 v78, v156, v152, s41
    v_perm_b32 v79, v164, v160, s41
    v_perm_b32 v80, v141, v137, s40
    v_perm_b32 v81, v149, v145, s40
    v_perm_b32 v82, v157, v153, s40
    v_perm_b32 v83, v165, v161, s40
    v_perm_b32 v84, v141, v137, s41
    v_perm_b32 v85, v149, v145, s41
    v_perm_b32 v86, v157, v153, s41
    v_perm_b32 v87, v165, v161, s41
    v_perm_b32 v88, v142, v138, s40
    v_perm_b32 v89, v150, v146, s40
    v_perm_b32 v90, v158, v154, s40
    v_perm_b32 v91, v166, v162, s40
    v_perm_b32 v92, v142, v138, s41
    v_perm_b32 v93, v150, v146, s41
    v_perm_b32 v94, v158, v154, s41
    v_perm_b32 v95, v166, v162, s41
    s_mov_b32 s44, 221184
    buffer_load_dwordx3 v[136:138], v68, s[16:19], s44 offen offset:0
    buffer_load_dwordx3 v[140:142], v68, s[16:19], s44 offen offset:2304
    buffer_load_dwordx3 v[144:146], v69, s[16:19], s44 offen offset:0
    buffer_load_dwordx3 v[148:150], v69, s[16:19], s44 offen offset:2304
    buffer_load_dwordx3 v[152:154], v70, s[16:19], s44 offen offset:0
    buffer_load_dwordx3 v[156:158], v70, s[16:19], s44 offen offset:2304
    buffer_load_dwordx3 v[160:162], v71, s[16:19], s44 offen offset:0
    buffer_load_dwordx3 v[164:166], v71, s[16:19], s44 offen offset:2304
    s_waitcnt lgkmcnt(0)
    v_mfma_f32_16x16x32_bf16 v[20:23], v[96:99], v[72:75], v[20:23]
    v_mfma_f32_16x16x32_bf16 v[24:27], v[100:103], v[72:75], v[24:27]
    v_mfma_f32_16x16x32_bf16 v[28:31], v[96:99], v[76:79], v[28:31]
    v_mfma_f32_16x16x32_bf16 v[32:35], v[100:103], v[76:79], v[32:35]
    v_mfma_f32_16x16x32_bf16 v[36:39], v[96:99], v[80:83], v[36:39]
    v_mfma_f32_16x16x32_bf16 v[40:43], v[100:103], v[80:83], v[40:43]
    v_mfma_f32_16x16x32_bf16 v[44:47], v[96:99], v[84:87], v[44:47]
    v_mfma_f32_16x16x32_bf16 v[48:51], v[100:103], v[84:87], v[48:51]
    v_mfma_f32_16x16x32_bf16 v[52:55], v[96:99], v[88:91], v[52:55]
    v_mfma_f32_16x16x32_bf16 v[56:59], v[100:103], v[88:91], v[56:59]
    v_mfma_f32_16x16x32_bf16 v[60:63], v[96:99], v[92:95], v[60:63]
    v_mfma_f32_16x16x32_bf16 v[64:67], v[100:103], v[92:95], v[64:67]
    ds_read_b128 v[96:99], v10 offset:2048
    ds_read_b128 v[100:103], v11 offset:2048
    s_waitcnt vmcnt(8)
    v_perm_b32 v72, v108, v104, s40
    v_perm_b32 v73, v116, v112, s40
    v_perm_b32 v74, v124, v120, s40
    v_perm_b32 v75, v132, v128, s40
    v_perm_b32 v76, v108, v104, s41
    v_perm_b32 v77, v116, v112, s41
    v_perm_b32 v78, v124, v120, s41
    v_perm_b32 v79, v132, v128, s41
    v_perm_b32 v80, v109, v105, s40
    v_perm_b32 v81, v117, v113, s40
    v_perm_b32 v82, v125, v121, s40
    v_perm_b32 v83, v133, v129, s40
    v_perm_b32 v84, v109, v105, s41
    v_perm_b32 v85, v117, v113, s41
    v_perm_b32 v86, v125, v121, s41
    v_perm_b32 v87, v133, v129, s41
    v_perm_b32 v88, v110, v106, s40
    v_perm_b32 v89, v118, v114, s40
    v_perm_b32 v90, v126, v122, s40
    v_perm_b32 v91, v134, v130, s40
    v_perm_b32 v92, v110, v106, s41
    v_perm_b32 v93, v118, v114, s41
    v_perm_b32 v94, v126, v122, s41
    v_perm_b32 v95, v134, v130, s41
    s_mov_b32 s44, 239616
    buffer_load_dwordx3 v[104:106], v68, s[16:19], s44 offen offset:0
    buffer_load_dwordx3 v[108:110], v68, s[16:19], s44 offen offset:2304
    buffer_load_dwordx3 v[112:114], v69, s[16:19], s44 offen offset:0
    buffer_load_dwordx3 v[116:118], v69, s[16:19], s44 offen offset:2304
    buffer_load_dwordx3 v[120:122], v70, s[16:19], s44 offen offset:0
    buffer_load_dwordx3 v[124:126], v70, s[16:19], s44 offen offset:2304
    buffer_load_dwordx3 v[128:130], v71, s[16:19], s44 offen offset:0
    buffer_load_dwordx3 v[132:134], v71, s[16:19], s44 offen offset:2304
    s_waitcnt lgkmcnt(0)
    v_mfma_f32_16x16x32_bf16 v[20:23], v[96:99], v[72:75], v[20:23]
    v_mfma_f32_16x16x32_bf16 v[24:27], v[100:103], v[72:75], v[24:27]
    v_mfma_f32_16x16x32_bf16 v[28:31], v[96:99], v[76:79], v[28:31]
    v_mfma_f32_16x16x32_bf16 v[32:35], v[100:103], v[76:79], v[32:35]
    v_mfma_f32_16x16x32_bf16 v[36:39], v[96:99], v[80:83], v[36:39]
    v_mfma_f32_16x16x32_bf16 v[40:43], v[100:103], v[80:83], v[40:43]
    v_mfma_f32_16x16x32_bf16 v[44:47], v[96:99], v[84:87], v[44:47]
    v_mfma_f32_16x16x32_bf16 v[48:51], v[100:103], v[84:87], v[48:51]
    v_mfma_f32_16x16x32_bf16 v[52:55], v[96:99], v[88:91], v[52:55]
    v_mfma_f32_16x16x32_bf16 v[56:59], v[100:103], v[88:91], v[56:59]
    v_mfma_f32_16x16x32_bf16 v[60:63], v[96:99], v[92:95], v[60:63]
    v_mfma_f32_16x16x32_bf16 v[64:67], v[100:103], v[92:95], v[64:67]
    ds_read_b128 v[96:99], v10 offset:3072
    ds_read_b128 v[100:103], v11 offset:3072
    s_waitcnt vmcnt(8)
    v_perm_b32 v72, v140, v136, s40
    v_perm_b32 v73, v148, v144, s40
    v_perm_b32 v74, v156, v152, s40
    v_perm_b32 v75, v164, v160, s40
    v_perm_b32 v76, v140, v136, s41
    v_perm_b32 v77, v148, v144, s41
    v_perm_b32 v78, v156, v152, s41
    v_perm_b32 v79, v164, v160, s41
    v_perm_b32 v80, v141, v137, s40
    v_perm_b32 v81, v149, v145, s40
    v_perm_b32 v82, v157, v153, s40
    v_perm_b32 v83, v165, v161, s40
    v_perm_b32 v84, v141, v137, s41
    v_perm_b32 v85, v149, v145, s41
    v_perm_b32 v86, v157, v153, s41
    v_perm_b32 v87, v165, v161, s41
    v_perm_b32 v88, v142, v138, s40
    v_perm_b32 v89, v150, v146, s40
    v_perm_b32 v90, v158, v154, s40
    v_perm_b32 v91, v166, v162, s40
    v_perm_b32 v92, v142, v138, s41
    v_perm_b32 v93, v150, v146, s41
    v_perm_b32 v94, v158, v154, s41
    v_perm_b32 v95, v166, v162, s41
    s_mov_b32 s44, 258048
    buffer_load_dwordx3 v[136:138], v68, s[16:19], s44 offen offset:0
    buffer_load_dwordx3 v[140:142], v68, s[16:19], s44 offen offset:2304
    buffer_load_dwordx3 v[144:146], v69, s[16:19], s44 offen offset:0
    buffer_load_dwordx3 v[148:150], v69, s[16:19], s44 offen offset:2304
    buffer_load_dwordx3 v[152:154], v70, s[16:19], s44 offen offset:0
    buffer_load_dwordx3 v[156:158], v70, s[16:19], s44 offen offset:2304
    buffer_load_dwordx3 v[160:162], v71, s[16:19], s44 offen offset:0
    buffer_load_dwordx3 v[164:166], v71, s[16:19], s44 offen offset:2304
    s_waitcnt lgkmcnt(0)
    v_mfma_f32_16x16x32_bf16 v[20:23], v[96:99], v[72:75], v[20:23]
    v_mfma_f32_16x16x32_bf16 v[24:27], v[100:103], v[72:75], v[24:27]
    v_mfma_f32_16x16x32_bf16 v[28:31], v[96:99], v[76:79], v[28:31]
    v_mfma_f32_16x16x32_bf16 v[32:35], v[100:103], v[76:79], v[32:35]
    v_mfma_f32_16x16x32_bf16 v[36:39], v[96:99], v[80:83], v[36:39]
    v_mfma_f32_16x16x32_bf16 v[40:43], v[100:103], v[80:83], v[40:43]
    v_mfma_f32_16x16x32_bf16 v[44:47], v[96:99], v[84:87], v[44:47]
    v_mfma_f32_16x16x32_bf16 v[48:51], v[100:103], v[84:87], v[48:51]
    v_mfma_f32_16x16x32_bf16 v[52:55], v[96:99], v[88:91], v[52:55]
    v_mfma_f32_16x16x32_bf16 v[56:59], v[100:103], v[88:91], v[56:59]
    v_mfma_f32_16x16x32_bf16 v[60:63], v[96:99], v[92:95], v[60:63]
    v_mfma_f32_16x16x32_bf16 v[64:67], v[100:103], v[92:95], v[64:67]
    ds_read_b128 v[96:99], v10 offset:4096
    ds_read_b128 v[100:103], v11 offset:4096
    s_waitcnt vmcnt(8)
    v_perm_b32 v72, v108, v104, s40
    v_perm_b32 v73, v116, v112, s40
    v_perm_b32 v74, v124, v120, s40
    v_perm_b32 v75, v132, v128, s40
    v_perm_b32 v76, v108, v104, s41
    v_perm_b32 v77, v116, v112, s41
    v_perm_b32 v78, v124, v120, s41
    v_perm_b32 v79, v132, v128, s41
    v_perm_b32 v80, v109, v105, s40
    v_perm_b32 v81, v117, v113, s40
    v_perm_b32 v82, v125, v121, s40
    v_perm_b32 v83, v133, v129, s40
    v_perm_b32 v84, v109, v105, s41
    v_perm_b32 v85, v117, v113, s41
    v_perm_b32 v86, v125, v121, s41
    v_perm_b32 v87, v133, v129, s41
    v_perm_b32 v88, v110, v106, s40
    v_perm_b32 v89, v118, v114, s40
    v_perm_b32 v90, v126, v122, s40
    v_perm_b32 v91, v134, v130, s40
    v_perm_b32 v92, v110, v106, s41
    v_perm_b32 v93, v118, v114, s41
    v_perm_b32 v94, v126, v122, s41
    v_perm_b32 v95, v134, v130, s41
    s_waitcnt lgkmcnt(0)
    v_mfma_f32_16x16x32_bf16 v[20:23], v[96:99], v[72:75], v[20:23]
    v_mfma_f32_16x16x32_bf16 v[24:27], v[100:103], v[72:75], v[24:27]
    v_mfma_f32_16x16x32_bf16 v[28:31], v[96:99], v[76:79], v[28:31]
    v_mfma_f32_16x16x32_bf16 v[32:35], v[100:103], v[76:79], v[32:35]
    v_mfma_f32_16x16x32_bf16 v[36:39], v[96:99], v[80:83], v[36:39]
    v_mfma_f32_16x16x32_bf16 v[40:43], v[100:103], v[80:83], v[40:43]
    v_mfma_f32_16x16x32_bf16 v[44:47], v[96:99], v[84:87], v[44:47]
    v_mfma_f32_16x16x32_bf16 v[48:51], v[100:103], v[84:87], v[48:51]
    v_mfma_f32_16x16x32_bf16 v[52:55], v[96:99], v[88:91], v[52:55]
    v_mfma_f32_16x16x32_bf16 v[56:59], v[100:103], v[88:91], v[56:59]
    v_mfma_f32_16x16x32_bf16 v[60:63], v[96:99], v[92:95], v[60:63]
    v_mfma_f32_16x16x32_bf16 v[64:67], v[100:103], v[92:95], v[64:67]
    ds_read_b128 v[96:99], v10 offset:5120
    ds_read_b128 v[100:103], v11 offset:5120
    s_waitcnt vmcnt(0)
    v_perm_b32 v72, v140, v136, s40
    v_perm_b32 v73, v148, v144, s40
    v_perm_b32 v74, v156, v152, s40
    v_perm_b32 v75, v164, v160, s40
    v_perm_b32 v76, v140, v136, s41
    v_perm_b32 v77, v148, v144, s41
    v_perm_b32 v78, v156, v152, s41
    v_perm_b32 v79, v164, v160, s41
    v_perm_b32 v80, v141, v137, s40
    v_perm_b32 v81, v149, v145, s40
    v_perm_b32 v82, v157, v153, s40
    v_perm_b32 v83, v165, v161, s40
    v_perm_b32 v84, v141, v137, s41
    v_perm_b32 v85, v149, v145, s41
    v_perm_b32 v86, v157, v153, s41
    v_perm_b32 v87, v165, v161, s41
    v_perm_b32 v88, v142, v138, s40
    v_perm_b32 v89, v150, v146, s40
    v_perm_b32 v90, v158, v154, s40
    v_perm_b32 v91, v166, v162, s40
    v_perm_b32 v92, v142, v138, s41
    v_perm_b32 v93, v150, v146, s41
    v_perm_b32 v94, v158, v154, s41
    v_perm_b32 v95, v166, v162, s41
    s_waitcnt lgkmcnt(0)
    v_mfma_f32_16x16x32_bf16 v[20:23], v[96:99], v[72:75], v[20:23]
    v_mfma_f32_16x16x32_bf16 v[24:27], v[100:103], v[72:75], v[24:27]
    v_mfma_f32_16x16x32_bf16 v[28:31], v[96:99], v[76:79], v[28:31]
    v_mfma_f32_16x16x32_bf16 v[32:35], v[100:103], v[76:79], v[32:35]
    v_mfma_f32_16x16x32_bf16 v[36:39], v[96:99], v[80:83], v[36:39]
    v_mfma_f32_16x16x32_bf16 v[40:43], v[100:103], v[80:83], v[40:43]
    v_mfma_f32_16x16x32_bf16 v[44:47], v[96:99], v[84:87], v[44:47]
    v_mfma_f32_16x16x32_bf16 v[48:51], v[100:103], v[84:87], v[48:51]
    v_mfma_f32_16x16x32_bf16 v[52:55], v[96:99], v[88:91], v[52:55]
    v_mfma_f32_16x16x32_bf16 v[56:59], v[100:103], v[88:91], v[56:59]
    v_mfma_f32_16x16x32_bf16 v[60:63], v[96:99], v[92:95], v[60:63]
    v_mfma_f32_16x16x32_bf16 v[64:67], v[100:103], v[92:95], v[64:67]
    s_lshl_b32 s44, s36, 1
    s_add_u32 s44, s44, s35
    s_mul_i32 s46, s44, 3072
    s_mul_i32 s45, s44, 6144
    s_add_u32 s45, s45, 65536
    v_add_u32 v10, s45, v4
    s_xor_b32 s44, s44, 1
    s_mul_i32 s45, s44, 6144
    s_add_u32 s45, s45, 65536
    v_add_u32 v11, s45, v4
    ds_write_b128 v11, v[24:27] offset:0
    ds_write_b128 v11, v[32:35] offset:1024
    ds_write_b128 v11, v[40:43] offset:2048
    ds_write_b128 v11, v[48:51] offset:3072
    ds_write_b128 v11, v[56:59] offset:4096
    ds_write_b128 v11, v[64:67] offset:5120
    s_waitcnt lgkmcnt(0)
    s_barrier
    ds_read_b128 v[24:27], v10 offset:0
    ds_read_b128 v[32:35], v10 offset:1024
    ds_read_b128 v[40:43], v10 offset:2048
    ds_read_b128 v[48:51], v10 offset:3072
    ds_read_b128 v[56:59], v10 offset:4096
    ds_read_b128 v[64:67], v10 offset:5120
    v_add_u32 v10, s46, v4
    s_waitcnt lgkmcnt(5)
    v_pk_add_f32 v[20:21], v[20:21], v[24:25]
    v_pk_add_f32 v[22:23], v[22:23], v[26:27]
    s_waitcnt lgkmcnt(4)
    v_pk_add_f32 v[28:29], v[28:29], v[32:33]
    v_pk_add_f32 v[30:31], v[30:31], v[34:35]
    s_waitcnt lgkmcnt(3)
    v_pk_add_f32 v[36:37], v[36:37], v[40:41]
    v_pk_add_f32 v[38:39], v[38:39], v[42:43]
    s_waitcnt lgkmcnt(2)
    v_pk_add_f32 v[44:45], v[44:45], v[48:49]
    v_pk_add_f32 v[46:47], v[46:47], v[50:51]
    s_waitcnt lgkmcnt(1)
    v_pk_add_f32 v[52:53], v[52:53], v[56:57]
    v_pk_add_f32 v[54:55], v[54:55], v[58:59]
    s_waitcnt lgkmcnt(0)
    v_pk_add_f32 v[60:61], v[60:61], v[64:65]
    v_pk_add_f32 v[62:63], v[62:63], v[66:67]
    v_cvt_pk_bf16_f32 v72, v20, v21
    v_cvt_pk_bf16_f32 v73, v22, v23
    v_mov_b32 v74, 0
    v_mov_b32 v75, 0
    v_cvt_pk_bf16_f32 v76, v28, v29
    v_cvt_pk_bf16_f32 v77, v30, v31
    v_mov_b32 v78, 0
    v_mov_b32 v79, 0
    v_cvt_pk_bf16_f32 v80, v36, v37
    v_cvt_pk_bf16_f32 v81, v38, v39
    v_mov_b32 v82, 0
    v_mov_b32 v83, 0
    v_cvt_pk_bf16_f32 v84, v44, v45
    v_cvt_pk_bf16_f32 v85, v46, v47
    v_mov_b32 v86, 0
    v_mov_b32 v87, 0
    v_cvt_pk_bf16_f32 v88, v52, v53
    v_cvt_pk_bf16_f32 v89, v54, v55
    v_mov_b32 v90, 0
    v_mov_b32 v91, 0
    v_cvt_pk_bf16_f32 v92, v60, v61
    v_cvt_pk_bf16_f32 v93, v62, v63
    v_mov_b32 v94, 0
    v_mov_b32 v95, 0
    v_lshrrev_b32 v11, 2, v2
    v_cmp_eq_u32 vcc, v11, v3
    s_mov_b32 s44, 0x3e16c740
    v_mov_b32 v102, 0
    v_mov_b32 v103, 0
    s_mul_i32 s46, s35, 3072
    v_add_u32 v10, s46, v4
    s_barrier
    ds_read_b128 v[104:107], v10 offset:0
    ds_read_b128 v[108:111], v10 offset:6144
    ds_read_b128 v[112:115], v10 offset:1024
    ds_read_b128 v[116:119], v10 offset:7168
    ds_read_b128 v[120:123], v10 offset:2048
    ds_read_b128 v[124:127], v10 offset:8192
    s_waitcnt lgkmcnt(4)
    v_mfma_f32_16x16x32_bf16 v[96:99], v[108:111], v[104:107], 0
    s_waitcnt lgkmcnt(2)
    v_mfma_f32_16x16x32_bf16 v[96:99], v[116:119], v[112:115], v[96:99]
    s_waitcnt lgkmcnt(0)
    v_mfma_f32_16x16x32_bf16 v[96:99], v[124:127], v[120:123], v[96:99]
    s_nop 7
    v_max3_f32 v68, v96, v97, v98
    v_max_f32 v68, v68, v99
    v_mul_f32 v68, s44, v68
    v_fma_f32 v96, v96, s44, -v68
    v_fma_f32 v97, v97, s44, -v68
    v_fma_f32 v98, v98, s44, -v68
    v_fma_f32 v99, v99, s44, -v68
    v_exp_f32 v96, v96
    v_exp_f32 v97, v97
    v_exp_f32 v98, v98
    v_exp_f32 v99, v99
    v_add_f32 v68, v96, v97
    v_add_f32 v69, v98, v99
    v_add_f32 v68, v68, v69
    v_rcp_f32 v68, v68
    s_nop 0
    v_mul_f32 v96, v96, v68
    v_mul_f32 v97, v97, v68
    v_mul_f32 v98, v98, v68
    v_mul_f32 v99, v99, v68
    v_cvt_pk_bf16_f32 v100, v96, v97
    v_cvt_pk_bf16_f32 v101, v98, v99
    v_cndmask_b32 v100, 0, v100, vcc
    v_cndmask_b32 v101, 0, v101, vcc
    s_nop 1
    v_mfma_f32_16x16x32_bf16 v[20:23], v[72:75], v[100:103], 0
    v_mfma_f32_16x16x32_bf16 v[24:27], v[76:79], v[100:103], 0
    v_mfma_f32_16x16x32_bf16 v[28:31], v[80:83], v[100:103], 0
    v_mfma_f32_16x16x32_bf16 v[32:35], v[84:87], v[100:103], 0
    v_mfma_f32_16x16x32_bf16 v[36:39], v[88:91], v[100:103], 0
    v_mfma_f32_16x16x32_bf16 v[40:43], v[92:95], v[100:103], 0
    s_nop 3
    v_cvt_pk_bf16_f32 v104, v20, v24
    s_nop 0
    v_cvt_pk_bf16_f32 v105, v28, v32
    s_nop 0
    v_cvt_pk_bf16_f32 v106, v36, v40
    v_cvt_pk_bf16_f32 v107, v21, v25
    v_cvt_pk_bf16_f32 v108, v29, v33
    v_cvt_pk_bf16_f32 v109, v37, v41
    v_cvt_pk_bf16_f32 v110, v22, v26
    v_cvt_pk_bf16_f32 v111, v30, v34
    v_cvt_pk_bf16_f32 v112, v38, v42
    v_cvt_pk_bf16_f32 v113, v23, v27
    v_cvt_pk_bf16_f32 v114, v31, v35
    v_cvt_pk_bf16_f32 v115, v39, v43
    ds_write_b128 v10, v[104:107] offset:28672
    ds_write_b128 v10, v[108:111] offset:29696
    ds_write_b128 v10, v[112:115] offset:30720
    s_waitcnt lgkmcnt(0)
    s_barrier
    s_lshl_b32 s38, s35, 2
    s_add_u32 s38, s38, s4
    s_lshl_b32 s38, s38, 7
    s_add_u32 s38, s38, 29684736
    s_mov_b32 s45, 65536
L5:
    s_load_dwordx8 s[48:55], s[8:9], s38 offset:0
    s_load_dwordx4 s[56:59], s[8:9], s38 offset:32
    s_waitcnt lgkmcnt(0)
    s_xor_b64 s[48:49], s[48:49], s[100:101]
    s_xor_b64 s[50:51], s[50:51], s[100:101]
    s_xor_b64 s[52:53], s[52:53], s[100:101]
    s_xor_b64 s[54:55], s[54:55], s[100:101]
    s_xor_b64 s[56:57], s[56:57], s[100:101]
    s_xor_b64 s[58:59], s[58:59], s[100:101]
    s_or_b64 s[48:49], s[48:49], s[50:51]
    s_or_b64 s[48:49], s[48:49], s[52:53]
    s_or_b64 s[48:49], s[48:49], s[54:55]
    s_or_b64 s[48:49], s[48:49], s[56:57]
    s_or_b64 s[48:49], s[48:49], s[58:59]
    s_cbranch_scc0 L6
    v_min_u32 v10, 11, v2
    v_lshl_add_u32 v10, v10, 2, s38
    s_mov_b32 s45, 32768
L7:
    buffer_load_dword v11, v10, s[8:11], 0 offen sc1
    s_waitcnt vmcnt(0)
    v_cmp_ne_u32 vcc, s43, v11
    s_nop 1
    s_cbranch_vccz L8
    s_sub_u32 s45, s45, 1
    s_cbranch_scc1 L8
    s_sleep 1
    s_branch L7
L8:
L6:
    s_mul_i32 s46, s4, 6
    s_add_u32 s46, s46, s3
    s_mul_i32 s46, s46, 24576
    s_add_u32 s46, s46, 24772608
    s_barrier
    s_add_u32 s44, s46, 0
    buffer_load_dwordx4 v[72:75], v4, s[8:11], s44 offen offset:0 sc1
    buffer_load_dwordx4 v[76:79], v4, s[8:11], s44 offen offset:1024 sc1
    buffer_load_dwordx4 v[80:83], v4, s[8:11], s44 offen offset:2048 sc1
    buffer_load_dwordx4 v[84:87], v4, s[8:11], s44 offen offset:3072 sc1
    s_add_u32 s44, s46, 4096
    buffer_load_dwordx4 v[88:91], v4, s[8:11], s44 offen offset:0 sc1
    buffer_load_dwordx4 v[92:95], v4, s[8:11], s44 offen offset:1024 sc1
    buffer_load_dwordx4 v[96:99], v4, s[8:11], s44 offen offset:2048 sc1
    buffer_load_dwordx4 v[100:103], v4, s[8:11], s44 offen offset:3072 sc1
    s_add_u32 s44, s46, 8192
    buffer_load_dwordx4 v[104:107], v4, s[8:11], s44 offen offset:0 sc1
    buffer_load_dwordx4 v[108:111], v4, s[8:11], s44 offen offset:1024 sc1
    buffer_load_dwordx4 v[112:115], v4, s[8:11], s44 offen offset:2048 sc1
    buffer_load_dwordx4 v[116:119], v4, s[8:11], s44 offen offset:3072 sc1
    s_add_u32 s44, s46, 12288
    buffer_load_dwordx4 v[120:123], v4, s[8:11], s44 offen offset:0 sc1
    buffer_load_dwordx4 v[124:127], v4, s[8:11], s44 offen offset:1024 sc1
    buffer_load_dwordx4 v[128:131], v4, s[8:11], s44 offen offset:2048 sc1
    buffer_load_dwordx4 v[132:135], v4, s[8:11], s44 offen offset:3072 sc1
    s_add_u32 s44, s46, 16384
    buffer_load_dwordx4 v[136:139], v4, s[8:11], s44 offen offset:0 sc1
    buffer_load_dwordx4 v[140:143], v4, s[8:11], s44 offen offset:1024 sc1
    buffer_load_dwordx4 v[144:147], v4, s[8:11], s44 offen offset:2048 sc1
    buffer_load_dwordx4 v[148:151], v4, s[8:11], s44 offen offset:3072 sc1
    s_add_u32 s44, s46, 20480
    buffer_load_dwordx4 v[152:155], v4, s[8:11], s44 offen offset:0 sc1
    buffer_load_dwordx4 v[156:159], v4, s[8:11], s44 offen offset:1024 sc1
    buffer_load_dwordx4 v[160:163], v4, s[8:11], s44 offen offset:2048 sc1
    buffer_load_dwordx4 v[164:167], v4, s[8:11], s44 offen offset:3072 sc1
    s_branch k2
k1_proj:
    s_sub_u32 s35, s3, 6
    s_lshl_b32 s44, s35, 1
    v_bfe_u32 v68, v2, 1, 1
    v_add_u32 v68, s44, v68
    v_mul_u32_u24 v69, 11, v68
    v_lshrrev_b32 v69, 5, v69
    v_mul_u32_u24 v69, 144, v69
    v_lshl_add_u32 v68, v68, 4, v69
    v_lshrrev_b32 v69, 2, v2
    v_mul_u32_u24 v69, 48, v69
    v_and_b32 v70, 1, v2
    v_lshlrev_b32 v70, 3, v70
    v_add3_u32 v68, v68, v69, v70
    v_mul_u32_u24 v69, 18432, v3
    v_add_u32 v68, v68, v69
    v_add_u32 v69, 3072, v68
    s_mul_i32 s46, s28, 73728
    v_mov_b32 v0, v9
    s_lshl_b32 s44, s3, 10
    v_add_u32 v5, s44, v4
    v_mul_u32_u24 v7, 192, v2
    s_lshl_b32 s44, s3, 4
    v_add_u32 v6, s44, v7
    v_lshrrev_b32 v8, 1, v6
    v_mad_u32_u24 v7, v3, 48, v7
    v_lshrrev_b32 v9, 1, v7
    s_lshl_b32 s44, s3, 2
    v_add_u32 v6, s44, v7
    v_lshrrev_b32 v11, 2, v2
    v_cmp_eq_u32 vcc, 0, v11
    s_nop 1
    v_cndmask_b32_e64 v60, 0, 1.0, vcc
    v_cmp_eq_u32 vcc, 1, v11
    s_nop 1
    v_cndmask_b32_e64 v61, 0, 1.0, vcc
    v_cmp_eq_u32 vcc, 2, v11
    s_nop 1
    v_cndmask_b32_e64 v62, 0, 1.0, vcc
    v_cmp_eq_u32 vcc, 3, v11
    s_nop 1
    v_cndmask_b32_e64 v63, 0, 1.0, vcc
    s_waitcnt vmcnt(0)
    v_lshlrev_b32 v28, 16, v20
    v_and_b32 v32, s42, v20
    v_lshlrev_b32 v29, 16, v21
    v_and_b32 v33, s42, v21
    v_lshlrev_b32 v30, 16, v22
    v_and_b32 v34, s42, v22
    v_lshlrev_b32 v31, 16, v23
    v_and_b32 v35, s42, v23
    s_waitcnt vmcnt(0)
    v_lshlrev_b32 v36, 16, v24
    v_and_b32 v40, s42, v24
    v_lshlrev_b32 v37, 16, v25
    v_and_b32 v41, s42, v25
    v_lshlrev_b32 v38, 16, v26
    v_and_b32 v42, s42, v26
    v_lshlrev_b32 v39, 16, v27
    v_and_b32 v43, s42, v27
    v_pk_add_f32 v[44:45], v[28:29], v[30:31]
    v_pk_mul_f32 v[46:47], v[28:29], v[28:29]
    v_pk_add_f32 v[44:45], v[44:45], v[32:33]
    v_pk_fma_f32 v[46:47], v[30:31], v[30:31], v[46:47]
    v_pk_add_f32 v[44:45], v[44:45], v[34:35]
    v_pk_fma_f32 v[46:47], v[32:33], v[32:33], v[46:47]
    v_pk_fma_f32 v[46:47], v[34:35], v[34:35], v[46:47]
    v_add_f32 v56, v44, v45
    v_add_f32 v57, v46, v47
    v_pk_add_f32 v[44:45], v[36:37], v[38:39]
    v_pk_mul_f32 v[46:47], v[36:37], v[36:37]
    v_pk_add_f32 v[44:45], v[44:45], v[40:41]
    v_pk_fma_f32 v[46:47], v[38:39], v[38:39], v[46:47]
    v_pk_add_f32 v[44:45], v[44:45], v[42:43]
    v_pk_fma_f32 v[46:47], v[40:41], v[40:41], v[46:47]
    v_pk_fma_f32 v[46:47], v[42:43], v[42:43], v[46:47]
    v_add_f32 v58, v44, v45
    v_add_f32 v59, v46, v47
    v_mfma_f32_16x16x4_f32 v[48:51], v60, v56, 0
    v_mfma_f32_16x16x4_f32 v[48:51], v61, v57, v[48:51]
    v_mfma_f32_16x16x4_f32 v[48:51], v62, v58, v[48:51]
    v_mfma_f32_16x16x4_f32 v[48:51], v63, v59, v[48:51]
    v_and_b32 v10, 3, v2
    v_cmp_eq_u32 vcc, v10, v3
    s_nop 1
    v_cndmask_b32_e64 v10, 0, 1.0, vcc
    s_nop 6
    ds_write_b32 v6, v48 offset:24576
    s_waitcnt lgkmcnt(0)
    s_barrier
    ds_read_b128 v[44:47], v7 offset:24576
    ds_read_b128 v[48:51], v7 offset:24592
    ds_read_b128 v[52:55], v7 offset:24608
    s_add_u32 s44, s46, 0
    buffer_load_dwordx2 v[120:121], v68, s[20:23], s44 offen offset:0
    buffer_load_dwordx2 v[122:123], v68, s[20:23], s44 offen offset:768
    buffer_load_dwordx2 v[124:125], v68, s[20:23], s44 offen offset:1536
    buffer_load_dwordx2 v[126:127], v68, s[20:23], s44 offen offset:2304
    buffer_load_dwordx2 v[128:129], v69, s[20:23], s44 offen offset:0
    buffer_load_dwordx2 v[130:131], v69, s[20:23], s44 offen offset:768
    buffer_load_dwordx2 v[132:133], v69, s[20:23], s44 offen offset:1536
    buffer_load_dwordx2 v[134:135], v69, s[20:23], s44 offen offset:2304
    s_waitcnt lgkmcnt(0)
    v_pk_add_f32 v[44:45], v[44:45], v[48:49]
    v_pk_add_f32 v[46:47], v[46:47], v[50:51]
    v_pk_add_f32 v[44:45], v[44:45], v[52:53]
    v_pk_add_f32 v[46:47], v[46:47], v[54:55]
    v_pk_add_f32 v[44:45], v[44:45], v[46:47]
    v_add_f32 v44, v44, v45
    s_nop 1
    v_mfma_f32_16x16x4_f32 v[56:59], v10, v44, 0
    s_nop 11
    v_mul_f32 v56, 0x3b2aaaab, v56
    v_mul_f32 v57, 0x3b2aaaab, v57
    v_fma_f32 v57, -v56, v56, v57
    v_max_f32 v57, 0, v57
    v_add_f32 v57, 0x3727c5ac, v57
    v_rsq_f32 v57, v57
    s_nop 0
    v_mul_f32 v56, -v56, v57
    v_mul_f32 v58, 0x3b2aaaab, v58
    v_mul_f32 v59, 0x3b2aaaab, v59
    v_fma_f32 v59, -v58, v58, v59
    v_max_f32 v59, 0, v59
    v_add_f32 v59, 0x3727c5ac, v59
    v_rsq_f32 v59, v59
    s_nop 0
    v_mul_f32 v58, -v58, v59
    v_pk_fma_f32 v[28:29], v[28:29], v[56:57], v[56:57] op_sel:[0,1,0] op_sel_hi:[1,1,0]
    v_pk_fma_f32 v[30:31], v[30:31], v[56:57], v[56:57] op_sel:[0,1,0] op_sel_hi:[1,1,0]
    v_pk_fma_f32 v[32:33], v[32:33], v[56:57], v[56:57] op_sel:[0,1,0] op_sel_hi:[1,1,0]
    v_pk_fma_f32 v[34:35], v[34:35], v[56:57], v[56:57] op_sel:[0,1,0] op_sel_hi:[1,1,0]
    v_cvt_pk_bf16_f32 v44, v28, v32
    v_cvt_pk_bf16_f32 v45, v29, v33
    v_cvt_pk_bf16_f32 v46, v30, v34
    v_cvt_pk_bf16_f32 v47, v31, v35
    ds_write_b128 v5, v[44:47] offset:0
    v_pk_fma_f32 v[36:37], v[36:37], v[58:59], v[58:59] op_sel:[0,1,0] op_sel_hi:[1,1,0]
    v_pk_fma_f32 v[38:39], v[38:39], v[58:59], v[58:59] op_sel:[0,1,0] op_sel_hi:[1,1,0]
    v_pk_fma_f32 v[40:41], v[40:41], v[58:59], v[58:59] op_sel:[0,1,0] op_sel_hi:[1,1,0]
    v_pk_fma_f32 v[42:43], v[42:43], v[58:59], v[58:59] op_sel:[0,1,0] op_sel_hi:[1,1,0]
    v_cvt_pk_bf16_f32 v48, v36, v40
    v_cvt_pk_bf16_f32 v49, v37, v41
    v_cvt_pk_bf16_f32 v50, v38, v42
    v_cvt_pk_bf16_f32 v51, v39, v43
    ds_write_b128 v5, v[48:51] offset:12288
    s_waitcnt lgkmcnt(0)
    s_barrier
    s_add_u32 s43, s43, 1
    s_mov_b32 s100, s43
    s_mov_b32 s101, s43
    s_add_u32 s44, s46, 6144
    buffer_load_dwordx2 v[136:137], v68, s[20:23], s44 offen offset:0
    buffer_load_dwordx2 v[138:139], v68, s[20:23], s44 offen offset:768
    buffer_load_dwordx2 v[140:141], v68, s[20:23], s44 offen offset:1536
    buffer_load_dwordx2 v[142:143], v68, s[20:23], s44 offen offset:2304
    buffer_load_dwordx2 v[144:145], v69, s[20:23], s44 offen offset:0
    buffer_load_dwordx2 v[146:147], v69, s[20:23], s44 offen offset:768
    buffer_load_dwordx2 v[148:149], v69, s[20:23], s44 offen offset:1536
    buffer_load_dwordx2 v[150:151], v69, s[20:23], s44 offen offset:2304
    s_barrier
    s_setprio 2
    s_add_u32 s44, s46, 12288
    buffer_load_dwordx2 v[152:153], v68, s[20:23], s44 offen offset:0
    buffer_load_dwordx2 v[154:155], v68, s[20:23], s44 offen offset:768
    buffer_load_dwordx2 v[156:157], v68, s[20:23], s44 offen offset:1536
    buffer_load_dwordx2 v[158:159], v68, s[20:23], s44 offen offset:2304
    buffer_load_dwordx2 v[160:161], v69, s[20:23], s44 offen offset:0
    buffer_load_dwordx2 v[162:163], v69, s[20:23], s44 offen offset:768
    buffer_load_dwordx2 v[164:165], v69, s[20:23], s44 offen offset:1536
    buffer_load_dwordx2 v[166:167], v69, s[20:23], s44 offen offset:2304
    s_barrier
    v_and_b32 v70, 3, v2
    v_lshlrev_b32 v70, 8, v70
    v_lshrrev_b32 v71, 2, v2
    v_lshl_add_u32 v71, v3, 2, v71
    v_lshl_add_u32 v70, v71, 4, v70
    s_mul_i32 s36, s29, 24576
    s_mul_i32 s44, s28, 1179648
    s_add_u32 s36, s36, s44
    s_lshl_b32 s44, s35, 12
    s_add_u32 s36, s36, s44
    s_lshr_b32 s37, s29, 2
    s_mul_i32 s37, s37, 6
    s_add_u32 s37, s37, s35
    s_lshl_b32 s37, s37, 7
    s_and_b32 s44, s29, 3
    s_lshl_b32 s44, s44, 4
    s_add_u32 s37, s37, s44
    s_lshl_b32 s44, s28, 2
    s_add_u32 s37, s37, s44
    s_add_u32 s37, s37, 29491200
    s_waitcnt vmcnt(16)
    v_perm_b32 v72, v122, v120, s40
    v_perm_b32 v73, v126, v124, s40
    v_perm_b32 v74, v130, v128, s40
    v_perm_b32 v75, v134, v132, s40
    v_perm_b32 v76, v122, v120, s41
    v_perm_b32 v77, v126, v124, s41
    v_perm_b32 v78, v130, v128, s41
    v_perm_b32 v79, v134, v132, s41
    v_perm_b32 v80, v123, v121, s40
    v_perm_b32 v81, v127, v125, s40
    v_perm_b32 v82, v131, v129, s40
    v_perm_b32 v83, v135, v133, s40
    v_perm_b32 v84, v123, v121, s41
    v_perm_b32 v85, v127, v125, s41
    v_perm_b32 v86, v131, v129, s41
    v_perm_b32 v87, v135, v133, s41
    s_waitcnt vmcnt(8)
    v_perm_b32 v88, v138, v136, s40
    v_perm_b32 v89, v142, v140, s40
    v_perm_b32 v90, v146, v144, s40
    v_perm_b32 v91, v150, v148, s40
    v_perm_b32 v92, v138, v136, s41
    v_perm_b32 v93, v142, v140, s41
    v_perm_b32 v94, v146, v144, s41
    v_perm_b32 v95, v150, v148, s41
    v_perm_b32 v96, v139, v137, s40
    v_perm_b32 v97, v143, v141, s40
    v_perm_b32 v98, v147, v145, s40
    v_perm_b32 v99, v151, v149, s40
    v_perm_b32 v100, v139, v137, s41
    v_perm_b32 v101, v143, v141, s41
    v_perm_b32 v102, v147, v145, s41
    v_perm_b32 v103, v151, v149, s41
    s_lshl_b32 s38, s4, 7
    s_add_u32 s38, s38, 29685760
    s_mov_b32 s45, 65536
L9:
    s_load_dwordx8 s[48:55], s[8:9], s38 offset:0
    s_load_dwordx4 s[56:59], s[8:9], s38 offset:32
    s_waitcnt lgkmcnt(0)
    s_xor_b64 s[48:49], s[48:49], s[100:101]
    s_xor_b64 s[50:51], s[50:51], s[100:101]
    s_xor_b64 s[52:53], s[52:53], s[100:101]
    s_xor_b64 s[54:55], s[54:55], s[100:101]
    s_xor_b64 s[56:57], s[56:57], s[100:101]
    s_xor_b64 s[58:59], s[58:59], s[100:101]
    s_or_b64 s[48:49], s[48:49], s[50:51]
    s_or_b64 s[48:49], s[48:49], s[52:53]
    s_or_b64 s[48:49], s[48:49], s[54:55]
    s_or_b64 s[48:49], s[48:49], s[56:57]
    s_or_b64 s[48:49], s[48:49], s[58:59]
    s_cbranch_scc0 L10
    v_min_u32 v10, 11, v2
    v_lshl_add_u32 v10, v10, 2, s38
    s_mov_b32 s45, 32768
L11:
    buffer_load_dword v11, v10, s[8:11], 0 offen sc1
    s_waitcnt vmcnt(0)
    v_cmp_ne_u32 vcc, s43, v11
    s_nop 1
    s_cbranch_vccz L12
    s_sub_u32 s45, s45, 1
    s_cbranch_scc1 L12
    s_sleep 1
    s_branch L11
L12:
L10:
    s_waitcnt vmcnt(0)
    v_perm_b32 v104, v154, v152, s40
    v_perm_b32 v105, v158, v156, s40
    v_perm_b32 v106, v162, v160, s40
    v_perm_b32 v107, v166, v164, s40
    v_perm_b32 v108, v154, v152, s41
    v_perm_b32 v109, v158, v156, s41
    v_perm_b32 v110, v162, v160, s41
    v_perm_b32 v111, v166, v164, s41
    v_perm_b32 v112, v155, v153, s40
    v_perm_b32 v113, v159, v157, s40
    v_perm_b32 v114, v163, v161, s40
    v_perm_b32 v115, v167, v165, s40
    v_perm_b32 v116, v155, v153, s41
    v_perm_b32 v117, v159, v157, s41
    v_perm_b32 v118, v163, v161, s41
    v_perm_b32 v119, v167, v165, s41
    s_barrier
    ds_read_b128 v[52:55], v4 offset:28672
    ds_read_b128 v[56:59], v4 offset:31744
    ds_read_b128 v[60:63], v4 offset:29696
    ds_read_b128 v[64:67], v4 offset:32768
    s_waitcnt lgkmcnt(2)
    v_mfma_f32_16x16x32_bf16 v[20:23], v[72:75], v[52:55], 0
    v_mfma_f32_16x16x32_bf16 v[24:27], v[72:75], v[56:59], 0
    v_mfma_f32_16x16x32_bf16 v[28:31], v[76:79], v[52:55], 0
    v_mfma_f32_16x16x32_bf16 v[32:35], v[76:79], v[56:59], 0
    v_mfma_f32_16x16x32_bf16 v[36:39], v[80:83], v[52:55], 0
    v_mfma_f32_16x16x32_bf16 v[40:43], v[80:83], v[56:59], 0
    v_mfma_f32_16x16x32_bf16 v[44:47], v[84:87], v[52:55], 0
    v_mfma_f32_16x16x32_bf16 v[48:51], v[84:87], v[56:59], 0
    ds_read_b128 v[52:55], v4 offset:30720
    ds_read_b128 v[56:59], v4 offset:33792
    s_waitcnt lgkmcnt(2)
    v_mfma_f32_16x16x32_bf16 v[20:23], v[88:91], v[60:63], v[20:23]
    v_mfma_f32_16x16x32_bf16 v[24:27], v[88:91], v[64:67], v[24:27]
    v_mfma_f32_16x16x32_bf16 v[28:31], v[92:95], v[60:63], v[28:31]
    v_mfma_f32_16x16x32_bf16 v[32:35], v[92:95], v[64:67], v[32:35]
    v_mfma_f32_16x16x32_bf16 v[36:39], v[96:99], v[60:63], v[36:39]
    v_mfma_f32_16x16x32_bf16 v[40:43], v[96:99], v[64:67], v[40:43]
    v_mfma_f32_16x16x32_bf16 v[44:47], v[100:103], v[60:63], v[44:47]
    v_mfma_f32_16x16x32_bf16 v[48:51], v[100:103], v[64:67], v[48:51]
    s_waitcnt lgkmcnt(0)
    v_mfma_f32_16x16x32_bf16 v[20:23], v[104:107], v[52:55], v[20:23]
    v_mfma_f32_16x16x32_bf16 v[24:27], v[104:107], v[56:59], v[24:27]
    v_mfma_f32_16x16x32_bf16 v[28:31], v[108:111], v[52:55], v[28:31]
    v_mfma_f32_16x16x32_bf16 v[32:35], v[108:111], v[56:59], v[32:35]
    v_mfma_f32_16x16x32_bf16 v[36:39], v[112:115], v[52:55], v[36:39]
    v_mfma_f32_16x16x32_bf16 v[40:43], v[112:115], v[56:59], v[40:43]
    v_mfma_f32_16x16x32_bf16 v[44:47], v[116:119], v[52:55], v[44:47]
    v_mfma_f32_16x16x32_bf16 v[48:51], v[116:119], v[56:59], v[48:51]
    s_nop 2
    v_cvt_pk_bf16_f32 v52, v20, v28
    s_nop 2
    v_cvt_pk_bf16_f32 v53, v36, v44
    v_cvt_pk_bf16_f32 v54, v21, v29
    v_cvt_pk_bf16_f32 v55, v37, v45
    buffer_store_dwordx4 v[52:55], v70, s[8:11], s36 offen offset:0 sc1
    v_cvt_pk_bf16_f32 v56, v22, v30
    v_cvt_pk_bf16_f32 v57, v38, v46
    v_cvt_pk_bf16_f32 v58, v23, v31
    v_cvt_pk_bf16_f32 v59, v39, v47
    buffer_store_dwordx4 v[56:59], v70, s[8:11], s36 offen offset:2048 sc1
    v_cvt_pk_bf16_f32 v60, v24, v32
    v_cvt_pk_bf16_f32 v61, v40, v48
    v_cvt_pk_bf16_f32 v62, v25, v33
    v_cvt_pk_bf16_f32 v63, v41, v49
    buffer_store_dwordx4 v[60:63], v70, s[8:11], s36 offen offset:1024 sc1
    v_cvt_pk_bf16_f32 v64, v26, v34
    v_cvt_pk_bf16_f32 v65, v42, v50
    v_cvt_pk_bf16_f32 v66, v27, v35
    v_cvt_pk_bf16_f32 v67, v43, v51
    buffer_store_dwordx4 v[64:67], v70, s[8:11], s36 offen offset:3072 sc1
    s_barrier
    v_mov_b32 v11, s43
    v_mov_b32 v10, 0
    s_waitcnt vmcnt(0)
    s_mov_b64 exec, 1
    buffer_store_dword v11, v10, s[8:11], s37 offen sc1
    s_mov_b64 exec, -1
    s_setprio 0
    s_mul_i32 s46, s4, 6
    s_add_u32 s46, s46, s35
    s_mul_i32 s46, s46, 12288
    s_add_u32 s46, s46, 25362432
    s_add_u32 s44, s46, 0
    buffer_load_dwordx4 v[120:123], v4, s[8:11], s44 offen offset:0 sc1
    buffer_load_dwordx4 v[124:127], v4, s[8:11], s44 offen offset:1024 sc1
    buffer_load_dwordx4 v[128:131], v4, s[8:11], s44 offen offset:2048 sc1
    buffer_load_dwordx4 v[132:135], v4, s[8:11], s44 offen offset:3072 sc1
    s_add_u32 s44, s46, 4096
    buffer_load_dwordx4 v[136:139], v4, s[8:11], s44 offen offset:0 sc1
    buffer_load_dwordx4 v[140:143], v4, s[8:11], s44 offen offset:1024 sc1
    buffer_load_dwordx4 v[144:147], v4, s[8:11], s44 offen offset:2048 sc1
    buffer_load_dwordx4 v[148:151], v4, s[8:11], s44 offen offset:3072 sc1
    s_add_u32 s44, s46, 8192
    buffer_load_dwordx4 v[152:155], v4, s[8:11], s44 offen offset:0 sc1
    buffer_load_dwordx4 v[156:159], v4, s[8:11], s44 offen offset:1024 sc1
    buffer_load_dwordx4 v[160:163], v4, s[8:11], s44 offen offset:2048 sc1
    buffer_load_dwordx4 v[164:167], v4, s[8:11], s44 offen offset:3072 sc1
k2:
    s_nop 7
    s_nop 3
    buffer_load_dwordx4 v[12:15], v0, s[12:15], s33 offen
    buffer_load_dwordx4 v[16:19], v0, s[12:15], s34 offen
    s_lshl_b32 s46, s3, 7
    s_add_u32 s47, s46, 29689344
    s_mul_i32 s44, s4, 24
    s_add_u32 s47, s47, s44
    s_add_u32 s46, s46, 29687808
    s_mul_i32 s39, s4, 12
    s_add_u32 s39, s39, s3
    s_lshr_b32 s64, s39, 2
    s_lshl_b32 s64, s64, 7
    s_add_u32 s64, s64, 29686272
    s_mov_b32 s45, 65536
L13:
    s_load_dwordx4 s[48:51], s[8:9], s46 offset:0
    s_load_dwordx2 s[52:53], s[8:9], s46 offset:16
    s_load_dwordx2 s[54:55], s[8:9], s47 offset:16
    s_load_dwordx4 s[56:59], s[8:9], s47 offset:0
    s_waitcnt lgkmcnt(0)
    s_xor_b64 s[48:49], s[48:49], s[100:101]
    s_xor_b64 s[50:51], s[50:51], s[100:101]
    s_xor_b64 s[52:53], s[52:53], s[100:101]
    s_xor_b64 s[54:55], s[54:55], s[100:101]
    s_xor_b64 s[56:57], s[56:57], s[100:101]
    s_xor_b64 s[58:59], s[58:59], s[100:101]
    s_or_b64 s[48:49], s[48:49], s[50:51]
    s_or_b64 s[48:49], s[48:49], s[52:53]
    s_or_b64 s[48:49], s[48:49], s[54:55]
    s_or_b64 s[48:49], s[48:49], s[56:57]
    s_or_b64 s[48:49], s[48:49], s[58:59]
    s_cbranch_scc0 L14
    v_min_u32 v10, 5, v2
    v_lshl_add_u32 v10, v10, 2, s46
    v_min_u32 v11, 5, v2
    v_lshl_add_u32 v11, v11, 2, s47
    v_cmp_eq_u32 vcc, 1, v3
    s_nop 1
    v_cndmask_b32 v10, v10, v11, vcc
    s_mov_b32 s45, 32768
L15:
    buffer_load_dword v11, v10, s[8:11], 0 offen sc1
    s_waitcnt vmcnt(0)
    v_cmp_ne_u32 vcc, s43, v11
    s_nop 1
    s_cbranch_vccz L16
    s_sub_u32 s45, s45, 1
    s_cbranch_scc1 L16
    s_sleep 1
    s_branch L15
L16:
L14:
    s_mov_b32 s45, 65536
L17:
    s_load_dwordx8 s[48:55], s[8:9], s64 offset:0
    s_load_dwordx4 s[56:59], s[8:9], s64 offset:32
    s_waitcnt lgkmcnt(0)
    s_xor_b64 s[48:49], s[48:49], s[100:101]
    s_xor_b64 s[50:51], s[50:51], s[100:101]
    s_xor_b64 s[52:53], s[52:53], s[100:101]
    s_xor_b64 s[54:55], s[54:55], s[100:101]
    s_xor_b64 s[56:57], s[56:57], s[100:101]
    s_xor_b64 s[58:59], s[58:59], s[100:101]
    s_or_b64 s[48:49], s[48:49], s[50:51]
    s_or_b64 s[48:49], s[48:49], s[52:53]
    s_or_b64 s[48:49], s[48:49], s[54:55]
    s_or_b64 s[48:49], s[48:49], s[56:57]
    s_or_b64 s[48:49], s[48:49], s[58:59]
    s_cbranch_scc0 L18
    v_min_u32 v10, 11, v2
    v_lshl_add_u32 v10, v10, 2, s64
    s_mov_b32 s45, 32768
L19:
    buffer_load_dword v11, v10, s[8:11], 0 offen sc1
    s_waitcnt vmcnt(0)
    v_cmp_ne_u32 vcc, s43, v11
    s_nop 1
    s_cbranch_vccz L20
    s_sub_u32 s45, s45, 1
    s_cbranch_scc1 L20
    s_sleep 1
    s_branch L19
L20:
L18:
    s_mul_i32 s65, s39, 24576
    s_add_u32 s65, s65, 27131904
    s_lshl_b32 s64, s3, 13
    s_add_u32 s64, s64, 65536
    s_mul_i32 s46, s6, 6
    s_lshr_b32 s44, s3, 1
    s_add_u32 s46, s46, s44
    s_lshl_b32 s46, s46, 7
    s_add_u32 s46, s46, 29491200
    s_mul_i32 s38, s31, 12288
    s_lshl_b32 s44, s3, 10
    s_add_u32 s38, s38, s44
    v_lshlrev_b32 v11, 2, v3
    v_sub_u32 v11, v2, v11
    v_cmp_eq_u32 vcc, 0, v11
    s_nop 1
    v_cndmask_b32_e64 v64, 0, 1.0, vcc
    v_lshrrev_b32 v60, 16, v64
    v_cmp_eq_u32 vcc, 1, v11
    s_nop 1
    v_cndmask_b32_e64 v65, 0, 1.0, vcc
    v_lshrrev_b32 v61, 16, v65
    v_cmp_eq_u32 vcc, 2, v11
    s_nop 1
    v_cndmask_b32_e64 v66, 0, 1.0, vcc
    v_lshrrev_b32 v62, 16, v66
    v_cmp_eq_u32 vcc, 3, v11
    s_nop 1
    v_cndmask_b32_e64 v67, 0, 1.0, vcc
    v_lshrrev_b32 v63, 16, v67
    v_lshrrev_b32 v11, 2, v2
    v_cmp_eq_u32 vcc, 0, v11
    s_nop 1
    v_cndmask_b32_e64 v68, 0, 1.0, vcc
    v_cmp_eq_u32 vcc, 1, v11
    s_nop 1
    v_cndmask_b32_e64 v69, 0, 1.0, vcc
    v_cmp_eq_u32 vcc, 2, v11
    s_nop 1
    v_cndmask_b32_e64 v70, 0, 1.0, vcc
    v_cmp_eq_u32 vcc, 3, v11
    s_nop 1
    v_cndmask_b32_e64 v71, 0, 1.0, vcc
    v_lshrrev_b32 v52, 3, v2
    v_mul_u32_u24 v52, 24576, v52
    v_bfe_u32 v53, v2, 2, 1
    v_lshl_add_u32 v52, v53, 10, v52
    v_lshl_add_u32 v52, v3, 6, v52
    v_and_b32 v53, 3, v2
    v_lshl_add_u32 v52, v53, 4, v52
    s_mul_i32 s47, s6, 98304
    s_lshl_b32 s44, s3, 11
    s_add_u32 s47, s47, s44
    s_lshl_b32 s44, s5, 8
    s_add_u32 s47, s47, s44
    s_mov_b32 s45, 65536
L21:
    s_load_dwordx16 s[48:63], s[8:9], s46 offset:0 glc
    s_waitcnt lgkmcnt(0)
    s_xor_b64 s[48:49], s[48:49], s[100:101]
    s_xor_b64 s[50:51], s[50:51], s[100:101]
    s_xor_b64 s[52:53], s[52:53], s[100:101]
    s_xor_b64 s[54:55], s[54:55], s[100:101]
    s_xor_b64 s[56:57], s[56:57], s[100:101]
    s_xor_b64 s[58:59], s[58:59], s[100:101]
    s_xor_b64 s[60:61], s[60:61], s[100:101]
    s_xor_b64 s[62:63], s[62:63], s[100:101]
    s_or_b64 s[48:49], s[48:49], s[50:51]
    s_or_b64 s[48:49], s[48:49], s[52:53]
    s_or_b64 s[48:49], s[48:49], s[54:55]
    s_or_b64 s[48:49], s[48:49], s[56:57]
    s_or_b64 s[48:49], s[48:49], s[58:59]
    s_or_b64 s[48:49], s[48:49], s[60:61]
    s_or_b64 s[48:49], s[48:49], s[62:63]
    s_cbranch_scc0 L22
    s_sub_u32 s45, s45, 1
    s_cbranch_scc1 L22
    s_sleep 3
    s_branch L21
L22:
    s_add_u32 s44, s47, 0
    buffer_load_dwordx4 v[20:23], v52, s[8:11], s44 offen sc1
    s_add_u32 s44, s47, 1179648
    buffer_load_dwordx4 v[24:27], v52, s[8:11], s44 offen sc1
    s_add_u32 s44, s47, 2359296
    buffer_load_dwordx4 v[28:31], v52, s[8:11], s44 offen sc1
    s_add_u32 s44, s47, 3538944
    buffer_load_dwordx4 v[32:35], v52, s[8:11], s44 offen sc1
    s_add_u32 s44, s47, 49152
    buffer_load_dwordx4 v[36:39], v52, s[8:11], s44 offen sc1
    s_add_u32 s44, s47, 1228800
    buffer_load_dwordx4 v[40:43], v52, s[8:11], s44 offen sc1
    s_add_u32 s44, s47, 2408448
    buffer_load_dwordx4 v[44:47], v52, s[8:11], s44 offen sc1
    s_add_u32 s44, s47, 3588096
    buffer_load_dwordx4 v[48:51], v52, s[8:11], s44 offen sc1
    s_waitcnt vmcnt(8)
    v_mfma_f32_16x16x32_bf16 v[52:55], v[60:63], v[12:15], 0
    v_mfma_f32_16x16x32_bf16 v[56:59], v[64:67], v[12:15], 0
    s_waitcnt vmcnt(7)
    v_mfma_f32_16x16x32_bf16 v[52:55], v[60:63], v[20:23], v[52:55]
    v_mfma_f32_16x16x32_bf16 v[56:59], v[64:67], v[20:23], v[56:59]
    s_waitcnt vmcnt(6)
    v_mfma_f32_16x16x32_bf16 v[52:55], v[60:63], v[24:27], v[52:55]
    v_mfma_f32_16x16x32_bf16 v[56:59], v[64:67], v[24:27], v[56:59]
    s_waitcnt vmcnt(5)
    v_mfma_f32_16x16x32_bf16 v[52:55], v[60:63], v[28:31], v[52:55]
    v_mfma_f32_16x16x32_bf16 v[56:59], v[64:67], v[28:31], v[56:59]
    s_waitcnt vmcnt(4)
    v_mfma_f32_16x16x32_bf16 v[52:55], v[60:63], v[32:35], v[52:55]
    v_mfma_f32_16x16x32_bf16 v[56:59], v[64:67], v[32:35], v[56:59]
    v_mfma_f32_16x16x32_bf16 v[20:23], v[60:63], v[16:19], 0
    v_mfma_f32_16x16x32_bf16 v[24:27], v[64:67], v[16:19], 0
    s_waitcnt vmcnt(3)
    v_mfma_f32_16x16x32_bf16 v[20:23], v[60:63], v[36:39], v[20:23]
    v_mfma_f32_16x16x32_bf16 v[24:27], v[64:67], v[36:39], v[24:27]
    s_waitcnt vmcnt(2)
    v_mfma_f32_16x16x32_bf16 v[20:23], v[60:63], v[40:43], v[20:23]
    v_mfma_f32_16x16x32_bf16 v[24:27], v[64:67], v[40:43], v[24:27]
    s_waitcnt vmcnt(1)
    v_mfma_f32_16x16x32_bf16 v[20:23], v[60:63], v[44:47], v[20:23]
    v_mfma_f32_16x16x32_bf16 v[24:27], v[64:67], v[44:47], v[24:27]
    s_waitcnt vmcnt(0)
    v_mfma_f32_16x16x32_bf16 v[20:23], v[60:63], v[48:51], v[20:23]
    v_mfma_f32_16x16x32_bf16 v[24:27], v[64:67], v[48:51], v[24:27]
    v_cvt_pk_bf16_f32 v12, v52, v56
    v_cvt_pk_bf16_f32 v13, v53, v57
    v_cvt_pk_bf16_f32 v14, v54, v58
    v_cvt_pk_bf16_f32 v15, v55, v59
    s_nop 1
    v_mfma_f32_16x16x32_bf16 v[52:55], v[60:63], v[12:15], 0
    v_mfma_f32_16x16x32_bf16 v[56:59], v[64:67], v[12:15], 0
    v_cvt_pk_bf16_f32 v16, v20, v24
    v_cvt_pk_bf16_f32 v17, v21, v25
    v_cvt_pk_bf16_f32 v18, v22, v26
    v_cvt_pk_bf16_f32 v19, v23, v27
    s_nop 1
    v_mfma_f32_16x16x32_bf16 v[20:23], v[60:63], v[16:19], 0
    v_mfma_f32_16x16x32_bf16 v[24:27], v[64:67], v[16:19], 0
    v_pk_add_f32 v[28:29], v[52:53], v[54:55]
    v_pk_mul_f32 v[30:31], v[52:53], v[52:53]
    v_pk_add_f32 v[28:29], v[28:29], v[56:57]
    v_pk_fma_f32 v[30:31], v[54:55], v[54:55], v[30:31]
    v_pk_add_f32 v[28:29], v[28:29], v[58:59]
    v_pk_fma_f32 v[30:31], v[56:57], v[56:57], v[30:31]
    v_pk_fma_f32 v[30:31], v[58:59], v[58:59], v[30:31]
    v_add_f32 v40, v28, v29
    v_add_f32 v41, v30, v31
    v_pk_add_f32 v[28:29], v[20:21], v[22:23]
    v_pk_mul_f32 v[30:31], v[20:21], v[20:21]
    v_pk_add_f32 v[28:29], v[28:29], v[24:25]
    v_pk_fma_f32 v[30:31], v[22:23], v[22:23], v[30:31]
    v_pk_add_f32 v[28:29], v[28:29], v[26:27]
    v_pk_fma_f32 v[30:31], v[24:25], v[24:25], v[30:31]
    v_pk_fma_f32 v[30:31], v[26:27], v[26:27], v[30:31]
    v_add_f32 v42, v28, v29
    v_add_f32 v43, v30, v31
    v_mfma_f32_16x16x4_f32 v[32:35], v68, v40, 0
    v_mfma_f32_16x16x4_f32 v[32:35], v69, v41, v[32:35]
    v_mfma_f32_16x16x4_f32 v[32:35], v70, v42, v[32:35]
    v_mfma_f32_16x16x4_f32 v[32:35], v71, v43, v[32:35]
    v_and_b32 v10, 3, v2
    v_cmp_eq_u32 vcc, v10, v3
    s_nop 1
    v_cndmask_b32_e64 v10, 0, 1.0, vcc
    s_nop 6
    ds_write_b32 v6, v32 offset:24576
    s_waitcnt lgkmcnt(0)
    s_barrier
    ds_read_b128 v[28:31], v7 offset:24576
    ds_read_b128 v[32:35], v7 offset:24592
    ds_read_b128 v[36:39], v7 offset:24608
    s_add_u32 m0, s64, 0
    s_add_u32 s44, s65, 16384
    buffer_load_dwordx4 v4, s[8:11], s44 offen offset:0 sc1 lds
    buffer_load_dwordx4 v4, s[8:11], s44 offen offset:1024 sc1 lds
    buffer_load_dwordx4 v4, s[8:11], s44 offen offset:2048 sc1 lds
    buffer_load_dwordx4 v4, s[8:11], s44 offen offset:3072 sc1 lds
    s_waitcnt lgkmcnt(0)
    v_pk_add_f32 v[28:29], v[28:29], v[32:33]
    v_pk_add_f32 v[30:31], v[30:31], v[34:35]
    v_pk_add_f32 v[28:29], v[28:29], v[36:37]
    v_pk_add_f32 v[30:31], v[30:31], v[38:39]
    v_pk_add_f32 v[28:29], v[28:29], v[30:31]
    v_add_f32 v28, v28, v29
    s_nop 1
    v_mfma_f32_16x16x4_f32 v[40:43], v10, v28, 0
    s_nop 11
    v_mul_f32 v40, 0x3b2aaaab, v40
    v_mul_f32 v41, 0x3b2aaaab, v41
    v_fma_f32 v41, -v40, v40, v41
    v_max_f32 v41, 0, v41
    v_add_f32 v41, 0x3727c5ac, v41
    v_rsq_f32 v41, v41
    s_nop 0
    v_mul_f32 v40, -v40, v41
    v_mul_f32 v42, 0x3b2aaaab, v42
    v_mul_f32 v43, 0x3b2aaaab, v43
    v_fma_f32 v43, -v42, v42, v43
    v_max_f32 v43, 0, v43
    v_add_f32 v43, 0x3727c5ac, v43
    v_rsq_f32 v43, v43
    s_nop 0
    v_mul_f32 v42, -v42, v43
    v_pk_fma_f32 v[52:53], v[52:53], v[40:41], v[40:41] op_sel:[0,1,0] op_sel_hi:[1,1,0]
    v_pk_fma_f32 v[54:55], v[54:55], v[40:41], v[40:41] op_sel:[0,1,0] op_sel_hi:[1,1,0]
    v_pk_fma_f32 v[56:57], v[56:57], v[40:41], v[40:41] op_sel:[0,1,0] op_sel_hi:[1,1,0]
    v_pk_fma_f32 v[58:59], v[58:59], v[40:41], v[40:41] op_sel:[0,1,0] op_sel_hi:[1,1,0]
    v_cvt_pk_bf16_f32 v28, v52, v56
    v_cvt_pk_bf16_f32 v29, v53, v57
    v_cvt_pk_bf16_f32 v30, v54, v58
    v_cvt_pk_bf16_f32 v31, v55, v59
    ds_write_b128 v5, v[28:31] offset:0
    v_pk_fma_f32 v[20:21], v[20:21], v[42:43], v[42:43] op_sel:[0,1,0] op_sel_hi:[1,1,0]
    v_pk_fma_f32 v[22:23], v[22:23], v[42:43], v[42:43] op_sel:[0,1,0] op_sel_hi:[1,1,0]
    v_pk_fma_f32 v[24:25], v[24:25], v[42:43], v[42:43] op_sel:[0,1,0] op_sel_hi:[1,1,0]
    v_pk_fma_f32 v[26:27], v[26:27], v[42:43], v[42:43] op_sel:[0,1,0] op_sel_hi:[1,1,0]
    v_cvt_pk_bf16_f32 v32, v20, v24
    v_cvt_pk_bf16_f32 v33, v21, v25
    v_cvt_pk_bf16_f32 v34, v22, v26
    v_cvt_pk_bf16_f32 v35, v23, v27
    ds_write_b128 v5, v[32:35] offset:12288
    s_waitcnt lgkmcnt(0)
    s_barrier
    s_add_u32 m0, s64, 4096
    s_add_u32 s44, s65, 20480
    buffer_load_dwordx4 v4, s[8:11], s44 offen offset:0 sc1 lds
    buffer_load_dwordx4 v4, s[8:11], s44 offen offset:1024 sc1 lds
    buffer_load_dwordx4 v4, s[8:11], s44 offen offset:2048 sc1 lds
    buffer_load_dwordx4 v4, s[8:11], s44 offen offset:3072 sc1 lds
    s_cmp_ge_u32 s3, 6
    s_cbranch_scc1 k2_v
    ds_read_b128 v[20:23], v4 offset:0
    ds_read_b128 v[24:27], v4 offset:12288
    ds_read_b128 v[28:31], v4 offset:1024
    ds_read_b128 v[32:35], v4 offset:13312
    s_waitcnt lgkmcnt(2)
    v_mfma_f32_16x16x32_bf16 v[36:39], v[72:75], v[20:23], 0
    v_mfma_f32_16x16x32_bf16 v[40:43], v[72:75], v[24:27], 0
    v_mfma_f32_16x16x32_bf16 v[44:47], v[76:79], v[20:23], 0
    v_mfma_f32_16x16x32_bf16 v[48:51], v[76:79], v[24:27], 0
    ds_read_b128 v[20:23], v4 offset:2048
    ds_read_b128 v[24:27], v4 offset:14336
    s_waitcnt lgkmcnt(2)
    v_mfma_f32_16x16x32_bf16 v[36:39], v[80:83], v[28:31], v[36:39]
    v_mfma_f32_16x16x32_bf16 v[40:43], v[80:83], v[32:35], v[40:43]
    v_mfma_f32_16x16x32_bf16 v[44:47], v[84:87], v[28:31], v[44:47]
    v_mfma_f32_16x16x32_bf16 v[48:51], v[84:87], v[32:35], v[48:51]
    ds_read_b128 v[28:31], v4 offset:3072
    ds_read_b128 v[32:35], v4 offset:15360
    s_waitcnt lgkmcnt(2)
    v_mfma_f32_16x16x32_bf16 v[36:39], v[88:91], v[20:23], v[36:39]
    v_mfma_f32_16x16x32_bf16 v[40:43], v[88:91], v[24:27], v[40:43]
    v_mfma_f32_16x16x32_bf16 v[44:47], v[92:95], v[20:23], v[44:47]
    v_mfma_f32_16x16x32_bf16 v[48:51], v[92:95], v[24:27], v[48:51]
    ds_read_b128 v[20:23], v4 offset:4096
    ds_read_b128 v[24:27], v4 offset:16384
    s_waitcnt lgkmcnt(2)
    v_mfma_f32_16x16x32_bf16 v[36:39], v[96:99], v[28:31], v[36:39]
    v_mfma_f32_16x16x32_bf16 v[40:43], v[96:99], v[32:35], v[40:43]
    v_mfma_f32_16x16x32_bf16 v[44:47], v[100:103], v[28:31], v[44:47]
    v_mfma_f32_16x16x32_bf16 v[48:51], v[100:103], v[32:35], v[48:51]
    ds_read_b128 v[28:31], v4 offset:5120
    ds_read_b128 v[32:35], v4 offset:17408
    s_waitcnt lgkmcnt(2)
    v_mfma_f32_16x16x32_bf16 v[36:39], v[104:107], v[20:23], v[36:39]
    v_mfma_f32_16x16x32_bf16 v[40:43], v[104:107], v[24:27], v[40:43]
    v_mfma_f32_16x16x32_bf16 v[44:47], v[108:111], v[20:23], v[44:47]
    v_mfma_f32_16x16x32_bf16 v[48:51], v[108:111], v[24:27], v[48:51]
    ds_read_b128 v[20:23], v4 offset:6144
    ds_read_b128 v[24:27], v4 offset:18432
    s_waitcnt lgkmcnt(2)
    v_mfma_f32_16x16x32_bf16 v[36:39], v[112:115], v[28:31], v[36:39]
    v_mfma_f32_16x16x32_bf16 v[40:43], v[112:115], v[32:35], v[40:43]
    v_mfma_f32_16x16x32_bf16 v[44:47], v[116:119], v[28:31], v[44:47]
    v_mfma_f32_16x16x32_bf16 v[48:51], v[116:119], v[32:35], v[48:51]
    ds_read_b128 v[28:31], v4 offset:7168
    ds_read_b128 v[32:35], v4 offset:19456
    s_waitcnt lgkmcnt(2)
    v_mfma_f32_16x16x32_bf16 v[36:39], v[120:123], v[20:23], v[36:39]
    v_mfma_f32_16x16x32_bf16 v[40:43], v[120:123], v[24:27], v[40:43]
    v_mfma_f32_16x16x32_bf16 v[44:47], v[124:127], v[20:23], v[44:47]
    v_mfma_f32_16x16x32_bf16 v[48:51], v[124:127], v[24:27], v[48:51]
    ds_read_b128 v[20:23], v4 offset:8192
    ds_read_b128 v[24:27], v4 offset:20480
    s_waitcnt lgkmcnt(2)
    v_mfma_f32_16x16x32_bf16 v[36:39], v[128:131], v[28:31], v[36:39]
    v_mfma_f32_16x16x32_bf16 v[40:43], v[128:131], v[32:35], v[40:43]
    v_mfma_f32_16x16x32_bf16 v[44:47], v[132:135], v[28:31], v[44:47]
    v_mfma_f32_16x16x32_bf16 v[48:51], v[132:135], v[32:35], v[48:51]
    ds_read_b128 v[28:31], v4 offset:9216
    ds_read_b128 v[32:35], v4 offset:21504
    s_waitcnt lgkmcnt(2)
    v_mfma_f32_16x16x32_bf16 v[36:39], v[136:139], v[20:23], v[36:39]
    v_mfma_f32_16x16x32_bf16 v[40:43], v[136:139], v[24:27], v[40:43]
    v_mfma_f32_16x16x32_bf16 v[44:47], v[140:143], v[20:23], v[44:47]
    v_mfma_f32_16x16x32_bf16 v[48:51], v[140:143], v[24:27], v[48:51]
    ds_read_b128 v[20:23], v4 offset:10240
    ds_read_b128 v[24:27], v4 offset:22528
    s_waitcnt lgkmcnt(2)
    v_mfma_f32_16x16x32_bf16 v[36:39], v[144:147], v[28:31], v[36:39]
    v_mfma_f32_16x16x32_bf16 v[40:43], v[144:147], v[32:35], v[40:43]
    v_mfma_f32_16x16x32_bf16 v[44:47], v[148:151], v[28:31], v[44:47]
    v_mfma_f32_16x16x32_bf16 v[48:51], v[148:151], v[32:35], v[48:51]
    ds_read_b128 v[28:31], v4 offset:11264
    ds_read_b128 v[32:35], v4 offset:23552
    s_waitcnt lgkmcnt(2)
    v_mfma_f32_16x16x32_bf16 v[36:39], v[152:155], v[20:23], v[36:39]
    v_mfma_f32_16x16x32_bf16 v[40:43], v[152:155], v[24:27], v[40:43]
    v_mfma_f32_16x16x32_bf16 v[44:47], v[156:159], v[20:23], v[44:47]
    v_mfma_f32_16x16x32_bf16 v[48:51], v[156:159], v[24:27], v[48:51]
    s_waitcnt lgkmcnt(0)
    v_mfma_f32_16x16x32_bf16 v[36:39], v[160:163], v[28:31], v[36:39]
    v_mfma_f32_16x16x32_bf16 v[40:43], v[160:163], v[32:35], v[40:43]
    v_mfma_f32_16x16x32_bf16 v[44:47], v[164:167], v[28:31], v[44:47]
    v_mfma_f32_16x16x32_bf16 v[48:51], v[164:167], v[32:35], v[48:51]
    s_nop 4
    v_cvt_pk_bf16_f32 v52, v36, v37
    v_cvt_pk_bf16_f32 v53, v38, v39
    v_cvt_pk_bf16_f32 v54, v44, v45
    v_cvt_pk_bf16_f32 v55, v46, v47
    v_cvt_pk_bf16_f32 v56, v40, v41
    v_cvt_pk_bf16_f32 v57, v42, v43
    v_cvt_pk_bf16_f32 v58, v48, v49
    v_cvt_pk_bf16_f32 v59, v50, v51
    s_cmp_ge_u32 s3, 3
    s_cbranch_scc1 k2_k
    ds_write_b128 v5, v[52:55] offset:34816
    ds_write_b128 v5, v[56:59] offset:37888
    s_branch k3
k2_k:
    s_mul_i32 s46, s7, 12
    s_add_u32 s46, s46, s6
    s_mul_i32 s44, s46, 6144
    s_lshl_b32 s45, s36, 10
    s_add_u32 s44, s44, s45
    s_add_u32 s44, s44, 7077888
    buffer_store_dwordx4 v[52:55], v4, s[8:11], s44 offen offset:0 sc1
    buffer_store_dwordx4 v[56:59], v4, s[8:11], s44 offen offset:3072 sc1
    s_lshl_b32 s46, s46, 7
    s_lshl_b32 s45, s36, 2
    s_add_u32 s46, s46, s45
    s_add_u32 s46, s46, 29500416
    v_mov_b32 v11, s43
    v_mov_b32 v10, 0
    s_waitcnt vmcnt(0)
    s_mov_b64 exec, 1
    buffer_store_dword v11, v10, s[8:11], s46 offen sc1
    s_mov_b64 exec, -1
    s_branch k3
k2_v:
    ds_read_b128 v[20:23], v4 offset:0
    ds_read_b128 v[24:27], v4 offset:12288
    ds_read_b128 v[28:31], v4 offset:1024
    ds_read_b128 v[32:35], v4 offset:13312
    s_waitcnt lgkmcnt(2)
    v_mfma_f32_16x16x32_bf16 v[36:39], v[20:23], v[120:123], 0
    v_mfma_f32_16x16x32_bf16 v[40:43], v[24:27], v[120:123], 0
    ds_read_b128 v[20:23], v4 offset:2048
    ds_read_b128 v[24:27], v4 offset:14336
    s_waitcnt lgkmcnt(2)
    v_mfma_f32_16x16x32_bf16 v[36:39], v[28:31], v[124:127], v[36:39]
    v_mfma_f32_16x16x32_bf16 v[40:43], v[32:35], v[124:127], v[40:43]
    ds_read_b128 v[28:31], v4 offset:3072
    ds_read_b128 v[32:35], v4 offset:15360
    s_waitcnt lgkmcnt(2)
    v_mfma_f32_16x16x32_bf16 v[36:39], v[20:23], v[128:131], v[36:39]
    v_mfma_f32_16x16x32_bf16 v[40:43], v[24:27], v[128:131], v[40:43]
    ds_read_b128 v[20:23], v4 offset:4096
    ds_read_b128 v[24:27], v4 offset:16384
    s_waitcnt lgkmcnt(2)
    v_mfma_f32_16x16x32_bf16 v[36:39], v[28:31], v[132:135], v[36:39]
    v_mfma_f32_16x16x32_bf16 v[40:43], v[32:35], v[132:135], v[40:43]
    ds_read_b128 v[28:31], v4 offset:5120
    ds_read_b128 v[32:35], v4 offset:17408
    s_waitcnt lgkmcnt(2)
    v_mfma_f32_16x16x32_bf16 v[36:39], v[20:23], v[136:139], v[36:39]
    v_mfma_f32_16x16x32_bf16 v[40:43], v[24:27], v[136:139], v[40:43]
    ds_read_b128 v[20:23], v4 offset:6144
    ds_read_b128 v[24:27], v4 offset:18432
    s_waitcnt lgkmcnt(2)
    v_mfma_f32_16x16x32_bf16 v[36:39], v[28:31], v[140:143], v[36:39]
    v_mfma_f32_16x16x32_bf16 v[40:43], v[32:35], v[140:143], v[40:43]
    ds_read_b128 v[28:31], v4 offset:7168
    ds_read_b128 v[32:35], v4 offset:19456
    s_waitcnt lgkmcnt(2)
    v_mfma_f32_16x16x32_bf16 v[36:39], v[20:23], v[144:147], v[36:39]
    v_mfma_f32_16x16x32_bf16 v[40:43], v[24:27], v[144:147], v[40:43]
    ds_read_b128 v[20:23], v4 offset:8192
    ds_read_b128 v[24:27], v4 offset:20480
    s_waitcnt lgkmcnt(2)
    v_mfma_f32_16x16x32_bf16 v[36:39], v[28:31], v[148:151], v[36:39]
    v_mfma_f32_16x16x32_bf16 v[40:43], v[32:35], v[148:151], v[40:43]
    ds_read_b128 v[28:31], v4 offset:9216
    ds_read_b128 v[32:35], v4 offset:21504
    s_waitcnt lgkmcnt(2)
    v_mfma_f32_16x16x32_bf16 v[36:39], v[20:23], v[152:155], v[36:39]
    v_mfma_f32_16x16x32_bf16 v[40:43], v[24:27], v[152:155], v[40:43]
    ds_read_b128 v[20:23], v4 offset:10240
    ds_read_b128 v[24:27], v4 offset:22528
    s_waitcnt lgkmcnt(2)
    v_mfma_f32_16x16x32_bf16 v[36:39], v[28:31], v[156:159], v[36:39]
    v_mfma_f32_16x16x32_bf16 v[40:43], v[32:35], v[156:159], v[40:43]
    ds_read_b128 v[28:31], v4 offset:11264
    ds_read_b128 v[32:35], v4 offset:23552
    s_waitcnt lgkmcnt(2)
    v_mfma_f32_16x16x32_bf16 v[36:39], v[20:23], v[160:163], v[36:39]
    v_mfma_f32_16x16x32_bf16 v[40:43], v[24:27], v[160:163], v[40:43]
    s_waitcnt lgkmcnt(0)
    v_mfma_f32_16x16x32_bf16 v[36:39], v[28:31], v[164:167], v[36:39]
    v_mfma_f32_16x16x32_bf16 v[40:43], v[32:35], v[164:167], v[40:43]
    s_nop 6
    v_cvt_pk_bf16_f32 v52, v36, v37
    v_cvt_pk_bf16_f32 v53, v38, v39
    v_cvt_pk_bf16_f32 v54, v40, v41
    v_cvt_pk_bf16_f32 v55, v42, v43
    s_mul_i32 s46, s7, 6
    s_add_u32 s46, s46, s35
    s_mul_i32 s44, s46, 12
    s_add_u32 s44, s44, s6
    s_lshl_b32 s44, s44, 10
    s_add_u32 s44, s44, 8257536
    buffer_store_dwordx4 v[52:55], v4, s[8:11], s44 offen sc1
    s_lshl_b32 s46, s46, 7
    s_lshl_b32 s45, s6, 2
    s_add_u32 s46, s46, s45
    s_add_u32 s46, s46, 29524992
    v_mov_b32 v11, s43
    v_mov_b32 v10, 0
    s_waitcnt vmcnt(0)
    s_mov_b64 exec, 1
    buffer_store_dword v11, v10, s[8:11], s46 offen sc1
    s_mov_b64 exec, -1
k3:
    s_nop 7
    s_nop 3
    s_mul_i32 s46, s39, 6144
    s_add_u32 s46, s46, 25657344
    s_add_u32 s44, s46, 0
    buffer_load_dwordx4 v[144:147], v4, s[8:11], s44 offen offset:0 sc1
    buffer_load_dwordx4 v[148:151], v4, s[8:11], s44 offen offset:1024 sc1
    buffer_load_dwordx4 v[152:155], v4, s[8:11], s44 offen offset:2048 sc1
    buffer_load_dwordx4 v[156:159], v4, s[8:11], s44 offen offset:3072 sc1
    s_add_u32 s44, s46, 4096
    buffer_load_dwordx4 v[160:163], v4, s[8:11], s44 offen offset:0 sc1
    buffer_load_dwordx4 v[164:167], v4, s[8:11], s44 offen offset:1024 sc1
    s_sub_u32 s39, s65, 1179648
    s_lshl_b32 s35, s69, 1
    s_add_u32 s35, s35, s3
    s_sub_u32 s44, s35, 12
    s_cmp_ge_u32 s35, 12
    s_cselect_b32 s35, s44, s35
    s_min_u32 s44, s3, 5
    s_add_u32 s69, s69, s44
    s_sub_u32 s44, s69, 6
    s_cmp_ge_u32 s69, 6
    s_cselect_b32 s69, s44, s69
    s_mul_i32 s46, s7, 12
    s_add_u32 s46, s46, s35
    s_mul_i32 s36, s46, 6144
    s_add_u32 s36, s36, 7077888
    s_lshl_b32 s46, s46, 7
    s_add_u32 s46, s46, 29500416
    s_mul_i32 s47, s7, 6
    s_add_u32 s47, s47, s69
    s_mul_i32 s37, s47, 12288
    s_add_u32 s37, s37, 8257536
    s_lshl_b32 s47, s47, 7
    s_add_u32 s47, s47, 29524992
    s_waitcnt lgkmcnt(0)
    s_barrier
    ds_read_b128 v[44:47], v4 offset:34816
    ds_read_b128 v[48:51], v4 offset:35840
    ds_read_b128 v[52:55], v4 offset:36864
    ds_read_b128 v[56:59], v4 offset:37888
    ds_read_b128 v[60:63], v4 offset:38912
    ds_read_b128 v[64:67], v4 offset:39936
    s_mov_b32 s45, 65536
L23:
    s_load_dwordx4 s[48:51], s[8:9], s46 offset:0 glc
    s_waitcnt lgkmcnt(0)
    s_mov_b32 s51, s43
    s_xor_b64 s[48:49], s[48:49], s[100:101]
    s_xor_b64 s[50:51], s[50:51], s[100:101]
    s_or_b64 s[48:49], s[48:49], s[50:51]
    s_cbranch_scc0 L24
    s_sub_u32 s45, s45, 1
    s_cbranch_scc1 L24
    s_sleep 3
    s_branch L23
L24:
    s_add_u32 s44, s36, 0
    buffer_load_dwordx4 v[20:23], v4, s[8:11], s44 offen offset:0 sc1
    buffer_load_dwordx4 v[24:27], v4, s[8:11], s44 offen offset:1024 sc1
    buffer_load_dwordx4 v[28:31], v4, s[8:11], s44 offen offset:2048 sc1
    buffer_load_dwordx4 v[32:35], v4, s[8:11], s44 offen offset:3072 sc1
    s_add_u32 s44, s36, 4096
    buffer_load_dwordx4 v[36:39], v4, s[8:11], s44 offen offset:0 sc1
    buffer_load_dwordx4 v[40:43], v4, s[8:11], s44 offen offset:1024 sc1
    s_mov_b32 s64, 0x3e16c740
    s_waitcnt lgkmcnt(0)
    s_waitcnt vmcnt(3)
    v_mfma_f32_16x16x32_bf16 v[68:71], v[20:23], v[44:47], 0
    v_mfma_f32_16x16x32_bf16 v[76:79], v[20:23], v[56:59], 0
    v_mfma_f32_16x16x32_bf16 v[68:71], v[24:27], v[48:51], v[68:71]
    v_mfma_f32_16x16x32_bf16 v[76:79], v[24:27], v[60:63], v[76:79]
    v_mfma_f32_16x16x32_bf16 v[68:71], v[28:31], v[52:55], v[68:71]
    v_mfma_f32_16x16x32_bf16 v[76:79], v[28:31], v[64:67], v[76:79]
    s_waitcnt vmcnt(0)
    v_mfma_f32_16x16x32_bf16 v[72:75], v[32:35], v[44:47], 0
    v_mfma_f32_16x16x32_bf16 v[80:83], v[32:35], v[56:59], 0
    v_mfma_f32_16x16x32_bf16 v[72:75], v[36:39], v[48:51], v[72:75]
    v_mfma_f32_16x16x32_bf16 v[80:83], v[36:39], v[60:63], v[80:83]
    v_mfma_f32_16x16x32_bf16 v[72:75], v[40:43], v[52:55], v[72:75]
    v_mfma_f32_16x16x32_bf16 v[80:83], v[40:43], v[64:67], v[80:83]
    s_cmp_ge_u32 s3, 6
    s_cbranch_scc1 k3_b
    s_mov_b32 s45, 65536
L25:
    s_load_dwordx8 s[48:55], s[8:9], s47 offset:0
    s_load_dwordx4 s[56:59], s[8:9], s47 offset:32
    s_waitcnt lgkmcnt(0)
    s_xor_b64 s[48:49], s[48:49], s[100:101]
    s_xor_b64 s[50:51], s[50:51], s[100:101]
    s_xor_b64 s[52:53], s[52:53], s[100:101]
    s_xor_b64 s[54:55], s[54:55], s[100:101]
    s_xor_b64 s[56:57], s[56:57], s[100:101]
    s_xor_b64 s[58:59], s[58:59], s[100:101]
    s_or_b64 s[48:49], s[48:49], s[50:51]
    s_or_b64 s[48:49], s[48:49], s[52:53]
    s_or_b64 s[48:49], s[48:49], s[54:55]
    s_or_b64 s[48:49], s[48:49], s[56:57]
    s_or_b64 s[48:49], s[48:49], s[58:59]
    s_cbranch_scc0 L26
    v_min_u32 v10, 11, v2
    v_lshl_add_u32 v10, v10, 2, s47
    s_mov_b32 s45, 32768
L27:
    buffer_load_dword v11, v10, s[8:11], 0 offen sc1
    s_waitcnt vmcnt(0)
    v_cmp_ne_u32 vcc, s43, v11
    s_nop 1
    s_cbranch_vccz L28
    s_sub_u32 s45, s45, 1
    s_cbranch_scc1 L28
    s_sleep 1
    s_branch L27
L28:
L26:
    s_add_u32 s44, s37, 0
    buffer_load_dwordx4 v[96:99], v4, s[8:11], s44 offen offset:0 sc1
    buffer_load_dwordx4 v[100:103], v4, s[8:11], s44 offen offset:1024 sc1
    buffer_load_dwordx4 v[104:107], v4, s[8:11], s44 offen offset:2048 sc1
    buffer_load_dwordx4 v[108:111], v4, s[8:11], s44 offen offset:3072 sc1
    s_add_u32 s44, s37, 4096
    buffer_load_dwordx4 v[112:115], v4, s[8:11], s44 offen offset:0 sc1
    buffer_load_dwordx4 v[116:119], v4, s[8:11], s44 offen offset:1024 sc1
    buffer_load_dwordx4 v[120:123], v4, s[8:11], s44 offen offset:2048 sc1
    buffer_load_dwordx4 v[124:127], v4, s[8:11], s44 offen offset:3072 sc1
    s_add_u32 s44, s37, 8192
    buffer_load_dwordx4 v[128:131], v4, s[8:11], s44 offen offset:0 sc1
    buffer_load_dwordx4 v[132:135], v4, s[8:11], s44 offen offset:1024 sc1
    buffer_load_dwordx4 v[136:139], v4, s[8:11], s44 offen offset:2048 sc1
    buffer_load_dwordx4 v[140:143], v4, s[8:11], s44 offen offset:3072 sc1
k3_b:
    s_nop 7
    v_max3_f32 v92, v68, v69, v70
    v_max3_f32 v92, v92, v71, v72
    v_max3_f32 v92, v92, v73, v74
    v_max_f32 v92, v92, v75
    v_max3_f32 v93, v76, v77, v78
    v_max3_f32 v93, v93, v79, v80
    v_max3_f32 v93, v93, v81, v82
    v_max_f32 v93, v93, v83
    v_mov_b32 v84, v92
    v_mov_b32 v85, v93
    s_nop 0
    v_permlane32_swap_b32 v92, v84
    v_permlane32_swap_b32 v93, v85
    v_max_f32 v92, v92, v84
    v_max_f32 v93, v93, v85
    v_mov_b32 v84, v92
    v_mov_b32 v85, v93
    s_nop 0
    v_permlane16_swap_b32 v92, v84
    v_permlane16_swap_b32 v93, v85
    v_max_f32 v92, v92, v84
    v_max_f32 v93, v93, v85
    ds_write_b64 v8, v[92:93] offset:24576
    s_lshl_b32 s44, s35, 11
    v_add_u32 v10, s44, v4
    s_waitcnt lgkmcnt(0)
    s_barrier
    ds_read_b64 v[84:85], v9 offset:24576
    ds_read_b64 v[86:87], v9 offset:24584
    ds_read_b64 v[88:89], v9 offset:24592
    s_waitcnt lgkmcnt(0)
    v_max3_f32 v92, v84, v86, v88
    v_max3_f32 v93, v85, v87, v89
    v_mov_b32 v84, v92
    v_mov_b32 v85, v93
    s_nop 0
    v_permlane32_swap_b32 v92, v84
    v_permlane32_swap_b32 v93, v85
    v_max_f32 v92, v92, v84
    v_max_f32 v93, v93, v85
    v_mov_b32 v84, v92
    v_mov_b32 v85, v93
    s_nop 0
    v_permlane16_swap_b32 v92, v84
    v_permlane16_swap_b32 v93, v85
    v_max_f32 v92, v92, v84
    v_max_f32 v93, v93, v85
    v_mul_f32 v92, s64, v92
    v_mul_f32 v93, s64, v93
    v_fma_f32 v68, v68, s64, -v92
    v_fma_f32 v69, v69, s64, -v92
    v_fma_f32 v70, v70, s64, -v92
    v_fma_f32 v71, v71, s64, -v92
    v_fma_f32 v72, v72, s64, -v92
    v_fma_f32 v73, v73, s64, -v92
    v_fma_f32 v74, v74, s64, -v92
    v_fma_f32 v75, v75, s64, -v92
    v_exp_f32 v68, v68
    v_exp_f32 v69, v69
    v_exp_f32 v70, v70
    v_exp_f32 v71, v71
    v_exp_f32 v72, v72
    v_exp_f32 v73, v73
    v_exp_f32 v74, v74
    v_exp_f32 v75, v75
    v_cvt_pk_bf16_f32 v84, v68, v69
    v_cvt_pk_bf16_f32 v85, v70, v71
    v_cvt_pk_bf16_f32 v86, v72, v73
    v_cvt_pk_bf16_f32 v87, v74, v75
    ds_write_b128 v10, v[84:87] offset:40960
    v_pk_add_f32 v[68:69], v[68:69], v[70:71]
    v_pk_add_f32 v[72:73], v[72:73], v[74:75]
    v_pk_add_f32 v[68:69], v[68:69], v[72:73]
    v_add_f32 v94, v68, v69
    v_fma_f32 v76, v76, s64, -v93
    v_fma_f32 v77, v77, s64, -v93
    v_fma_f32 v78, v78, s64, -v93
    v_fma_f32 v79, v79, s64, -v93
    v_fma_f32 v80, v80, s64, -v93
    v_fma_f32 v81, v81, s64, -v93
    v_fma_f32 v82, v82, s64, -v93
    v_fma_f32 v83, v83, s64, -v93
    v_exp_f32 v76, v76
    v_exp_f32 v77, v77
    v_exp_f32 v78, v78
    v_exp_f32 v79, v79
    v_exp_f32 v80, v80
    v_exp_f32 v81, v81
    v_exp_f32 v82, v82
    v_exp_f32 v83, v83
    v_cvt_pk_bf16_f32 v88, v76, v77
    v_cvt_pk_bf16_f32 v89, v78, v79
    v_cvt_pk_bf16_f32 v90, v80, v81
    v_cvt_pk_bf16_f32 v91, v82, v83
    ds_write_b128 v10, v[88:91] offset:41984
    v_pk_add_f32 v[76:77], v[76:77], v[78:79]
    v_pk_add_f32 v[80:81], v[80:81], v[82:83]
    v_pk_add_f32 v[76:77], v[76:77], v[80:81]
    v_add_f32 v95, v76, v77
    v_mov_b32 v68, v94
    v_mov_b32 v69, v95
    s_nop 0
    v_permlane32_swap_b32 v94, v68
    v_permlane32_swap_b32 v95, v69
    v_add_f32 v94, v94, v68
    v_add_f32 v95, v95, v69
    v_mov_b32 v68, v94
    v_mov_b32 v69, v95
    s_nop 0
    v_permlane16_swap_b32 v94, v68
    v_permlane16_swap_b32 v95, v69
    v_add_f32 v94, v94, v68
    v_add_f32 v95, v95, v69
    ds_write_b64 v8, v[94:95] offset:26112
    s_cmp_lt_u32 s3, 6
    s_cbranch_scc1 k3_c
    s_add_u32 s44, s39, 0
    buffer_load_dwordx4 v[96:99], v4, s[8:11], s44 offen offset:0 sc1
    buffer_load_dwordx4 v[100:103], v4, s[8:11], s44 offen offset:1024 sc1
    buffer_load_dwordx4 v[104:107], v4, s[8:11], s44 offen offset:2048 sc1
    buffer_load_dwordx4 v[108:111], v4, s[8:11], s44 offen offset:3072 sc1
    s_add_u32 s44, s39, 4096
    buffer_load_dwordx4 v[112:115], v4, s[8:11], s44 offen offset:0 sc1
    buffer_load_dwordx4 v[116:119], v4, s[8:11], s44 offen offset:1024 sc1
    buffer_load_dwordx4 v[120:123], v4, s[8:11], s44 offen offset:2048 sc1
    buffer_load_dwordx4 v[124:127], v4, s[8:11], s44 offen offset:3072 sc1
k3_c:
    s_waitcnt lgkmcnt(0)
    s_barrier
    s_cmp_lt_u32 s3, 6
    s_cbranch_scc1 k3_pv
    s_add_u32 s44, s39, 8192
    buffer_load_dwordx4 v[128:131], v4, s[8:11], s44 offen offset:0 sc1
    buffer_load_dwordx4 v[132:135], v4, s[8:11], s44 offen offset:1024 sc1
    buffer_load_dwordx4 v[136:139], v4, s[8:11], s44 offen offset:2048 sc1
    buffer_load_dwordx4 v[140:143], v4, s[8:11], s44 offen offset:3072 sc1
    s_add_u32 s44, s39, 12288
    buffer_load_dwordx4 v[20:23], v4, s[8:11], s44 offen offset:0 sc1
    buffer_load_dwordx4 v[24:27], v4, s[8:11], s44 offen offset:1024 sc1
    buffer_load_dwordx4 v[28:31], v4, s[8:11], s44 offen offset:2048 sc1
    buffer_load_dwordx4 v[32:35], v4, s[8:11], s44 offen offset:3072 sc1
    s_add_u32 s44, s39, 16384
    buffer_load_dwordx4 v[36:39], v4, s[8:11], s44 offen offset:0 sc1
    buffer_load_dwordx4 v[40:43], v4, s[8:11], s44 offen offset:1024 sc1
    buffer_load_dwordx4 v[44:47], v4, s[8:11], s44 offen offset:2048 sc1
    buffer_load_dwordx4 v[48:51], v4, s[8:11], s44 offen offset:3072 sc1
    s_add_u32 s44, s39, 20480
    buffer_load_dwordx4 v[52:55], v4, s[8:11], s44 offen offset:0 sc1
    buffer_load_dwordx4 v[56:59], v4, s[8:11], s44 offen offset:1024 sc1
    buffer_load_dwordx4 v[60:63], v4, s[8:11], s44 offen offset:2048 sc1
    buffer_load_dwordx4 v[64:67], v4, s[8:11], s44 offen offset:3072 sc1
    s_branch k3_o
k3_pv:
    ds_read_b128 v[20:23], v4 offset:40960
    ds_read_b128 v[24:27], v4 offset:41984
    ds_read_b128 v[28:31], v4 offset:43008
    ds_read_b128 v[32:35], v4 offset:44032
    ds_read_b128 v[36:39], v4 offset:45056
    ds_read_b128 v[40:43], v4 offset:46080
    ds_read_b128 v[44:47], v4 offset:47104
    ds_read_b128 v[48:51], v4 offset:48128
    ds_read_b128 v[52:55], v4 offset:49152
    ds_read_b128 v[56:59], v4 offset:50176
    ds_read_b128 v[60:63], v4 offset:51200
    ds_read_b128 v[64:67], v4 offset:52224
    s_waitcnt vmcnt(11) lgkmcnt(10)
    v_mfma_f32_16x16x32_bf16 v[68:71], v[96:99], v[20:23], 0
    v_mfma_f32_16x16x32_bf16 v[72:75], v[96:99], v[24:27], 0
    s_waitcnt vmcnt(10) lgkmcnt(8)
    v_mfma_f32_16x16x32_bf16 v[68:71], v[100:103], v[28:31], v[68:71]
    v_mfma_f32_16x16x32_bf16 v[72:75], v[100:103], v[32:35], v[72:75]
    ds_read_b128 v[20:23], v4 offset:53248
    ds_read_b128 v[24:27], v4 offset:54272
    s_waitcnt vmcnt(9) lgkmcnt(8)
    v_mfma_f32_16x16x32_bf16 v[68:71], v[104:107], v[36:39], v[68:71]
    v_mfma_f32_16x16x32_bf16 v[72:75], v[104:107], v[40:43], v[72:75]
    ds_read_b128 v[28:31], v4 offset:55296
    ds_read_b128 v[32:35], v4 offset:56320
    s_waitcnt vmcnt(8) lgkmcnt(8)
    v_mfma_f32_16x16x32_bf16 v[68:71], v[108:111], v[44:47], v[68:71]
    v_mfma_f32_16x16x32_bf16 v[72:75], v[108:111], v[48:51], v[72:75]
    ds_read_b128 v[36:39], v4 offset:57344
    ds_read_b128 v[40:43], v4 offset:58368
    s_waitcnt vmcnt(7) lgkmcnt(8)
    v_mfma_f32_16x16x32_bf16 v[68:71], v[112:115], v[52:55], v[68:71]
    v_mfma_f32_16x16x32_bf16 v[72:75], v[112:115], v[56:59], v[72:75]
    ds_read_b128 v[44:47], v4 offset:59392
    ds_read_b128 v[48:51], v4 offset:60416
    s_waitcnt vmcnt(6) lgkmcnt(8)
    v_mfma_f32_16x16x32_bf16 v[68:71], v[116:119], v[60:63], v[68:71]
    v_mfma_f32_16x16x32_bf16 v[72:75], v[116:119], v[64:67], v[72:75]
    ds_read_b128 v[52:55], v4 offset:61440
    ds_read_b128 v[56:59], v4 offset:62464
    s_waitcnt vmcnt(5) lgkmcnt(8)
    v_mfma_f32_16x16x32_bf16 v[68:71], v[120:123], v[20:23], v[68:71]
    v_mfma_f32_16x16x32_bf16 v[72:75], v[120:123], v[24:27], v[72:75]
    ds_read_b128 v[60:63], v4 offset:63488
    ds_read_b128 v[64:67], v4 offset:64512
    s_waitcnt vmcnt(4) lgkmcnt(8)
    v_mfma_f32_16x16x32_bf16 v[68:71], v[124:127], v[28:31], v[68:71]
    v_mfma_f32_16x16x32_bf16 v[72:75], v[124:127], v[32:35], v[72:75]
    s_waitcnt vmcnt(3) lgkmcnt(6)
    v_mfma_f32_16x16x32_bf16 v[68:71], v[128:131], v[36:39], v[68:71]
    v_mfma_f32_16x16x32_bf16 v[72:75], v[128:131], v[40:43], v[72:75]
    s_waitcnt vmcnt(2) lgkmcnt(4)
    v_mfma_f32_16x16x32_bf16 v[68:71], v[132:135], v[44:47], v[68:71]
    v_mfma_f32_16x16x32_bf16 v[72:75], v[132:135], v[48:51], v[72:75]
    s_waitcnt vmcnt(1) lgkmcnt(2)
    v_mfma_f32_16x16x32_bf16 v[68:71], v[136:139], v[52:55], v[68:71]
    v_mfma_f32_16x16x32_bf16 v[72:75], v[136:139], v[56:59], v[72:75]
    s_waitcnt vmcnt(0) lgkmcnt(0)
    v_mfma_f32_16x16x32_bf16 v[68:71], v[140:143], v[60:63], v[68:71]
    v_mfma_f32_16x16x32_bf16 v[72:75], v[140:143], v[64:67], v[72:75]
    s_lshr_b32 s44, s69, 1
    s_lshl_b32 s44, s44, 10
    s_and_b32 s45, s69, 1
    s_lshl_b32 s45, s45, 3
    s_add_u32 s44, s44, s45
    v_add_u32 v10, s44, v4
    ds_read_b64 v[84:85], v9 offset:26112
    ds_read_b64 v[86:87], v9 offset:26120
    ds_read_b64 v[88:89], v9 offset:26128
    s_waitcnt lgkmcnt(0)
    v_add_f32 v92, v84, v86
    v_add_f32 v92, v92, v88
    v_add_f32 v93, v85, v87
    v_add_f32 v93, v93, v89
    v_mov_b32 v84, v92
    v_mov_b32 v85, v93
    s_nop 0
    v_permlane32_swap_b32 v92, v84
    v_permlane32_swap_b32 v93, v85
    v_add_f32 v92, v92, v84
    v_add_f32 v93, v93, v85
    v_mov_b32 v84, v92
    v_mov_b32 v85, v93
    s_nop 0
    v_permlane16_swap_b32 v92, v84
    v_permlane16_swap_b32 v93, v85
    v_add_f32 v92, v92, v84
    v_add_f32 v93, v93, v85
    v_rcp_f32 v92, v92
    v_rcp_f32 v93, v93
    v_mul_f32 v68, v68, v92
    v_mul_f32 v69, v69, v92
    v_mul_f32 v70, v70, v92
    v_mul_f32 v71, v71, v92
    v_cvt_pk_bf16_f32 v68, v68, v69
    v_cvt_pk_bf16_f32 v69, v70, v71
    ds_write_b64 v10, v[68:69] offset:28672
    v_mul_f32 v72, v72, v93
    v_mul_f32 v73, v73, v93
    v_mul_f32 v74, v74, v93
    v_mul_f32 v75, v75, v93
    v_cvt_pk_bf16_f32 v72, v72, v73
    v_cvt_pk_bf16_f32 v73, v74, v75
    ds_write_b64 v10, v[72:73] offset:31744
    s_waitcnt lgkmcnt(0)
k3_o:
    s_barrier
    s_setprio 2
    ds_read_b128 v[84:87], v4 offset:28672
    ds_read_b128 v[88:91], v4 offset:31744
    ds_read_b128 v[92:95], v4 offset:29696
    s_waitcnt lgkmcnt(2)
    v_mfma_f32_16x16x32_bf16 v[68:71], v[144:147], v[84:87], 0
    v_mfma_f32_16x16x32_bf16 v[76:79], v[148:151], v[84:87], 0
    ds_read_b128 v[84:87], v4 offset:32768
    s_waitcnt lgkmcnt(2)
    v_mfma_f32_16x16x32_bf16 v[72:75], v[144:147], v[88:91], 0
    v_mfma_f32_16x16x32_bf16 v[80:83], v[148:151], v[88:91], 0
    ds_read_b128 v[88:91], v4 offset:30720
    s_waitcnt lgkmcnt(2)
    v_mfma_f32_16x16x32_bf16 v[68:71], v[152:155], v[92:95], v[68:71]
    v_mfma_f32_16x16x32_bf16 v[76:79], v[156:159], v[92:95], v[76:79]
    ds_read_b128 v[92:95], v4 offset:33792
    s_waitcnt lgkmcnt(2)
    v_mfma_f32_16x16x32_bf16 v[72:75], v[152:155], v[84:87], v[72:75]
    v_mfma_f32_16x16x32_bf16 v[80:83], v[156:159], v[84:87], v[80:83]
    s_waitcnt lgkmcnt(1)
    v_mfma_f32_16x16x32_bf16 v[68:71], v[160:163], v[88:91], v[68:71]
    v_mfma_f32_16x16x32_bf16 v[76:79], v[164:167], v[88:91], v[76:79]
    s_waitcnt lgkmcnt(0)
    v_mfma_f32_16x16x32_bf16 v[72:75], v[160:163], v[92:95], v[72:75]
    v_mfma_f32_16x16x32_bf16 v[80:83], v[164:167], v[92:95], v[80:83]
    s_mul_i32 s44, s4, 1179648
    s_add_u32 s36, s38, s44
    s_add_u32 s44, s36, 9437184
    s_add_u32 s45, s44, 12288
    s_mul_i32 s37, s30, 12
    s_add_u32 s37, s37, s3
    s_lshl_b32 s37, s37, 7
    s_add_u32 s46, s37, 29537280
    s_lshl_b32 s47, s4, 2
    s_add_u32 s47, s47, s46
    v_cvt_pk_bf16_f32 v84, v68, v76
    v_cvt_pk_bf16_f32 v85, v69, v77
    v_cvt_pk_bf16_f32 v86, v70, v78
    v_cvt_pk_bf16_f32 v87, v71, v79
    buffer_store_dwordx4 v[84:87], v4, s[8:11], s44 offen sc1
    v_cvt_pk_bf16_f32 v88, v72, v80
    v_cvt_pk_bf16_f32 v89, v73, v81
    v_cvt_pk_bf16_f32 v90, v74, v82
    v_cvt_pk_bf16_f32 v91, v75, v83
    buffer_store_dwordx4 v[88:91], v4, s[8:11], s45 offen sc1
    v_mov_b32 v11, s43
    v_mov_b32 v10, 0
    s_waitcnt vmcnt(0)
    s_mov_b64 exec, 1
    buffer_store_dword v11, v10, s[8:11], s47 offen sc1
    s_mov_b64 exec, -1
    s_setprio 0
    s_cmp_ge_u32 s3, 6
    s_cbranch_scc1 k4_h
    s_add_u32 s44, s39, 0
    buffer_load_dwordx4 v[96:99], v4, s[8:11], s44 offen offset:0 sc1
    buffer_load_dwordx4 v[100:103], v4, s[8:11], s44 offen offset:1024 sc1
    buffer_load_dwordx4 v[104:107], v4, s[8:11], s44 offen offset:2048 sc1
    buffer_load_dwordx4 v[108:111], v4, s[8:11], s44 offen offset:3072 sc1
    s_add_u32 s44, s39, 4096
    buffer_load_dwordx4 v[112:115], v4, s[8:11], s44 offen offset:0 sc1
    buffer_load_dwordx4 v[116:119], v4, s[8:11], s44 offen offset:1024 sc1
    buffer_load_dwordx4 v[120:123], v4, s[8:11], s44 offen offset:2048 sc1
    buffer_load_dwordx4 v[124:127], v4, s[8:11], s44 offen offset:3072 sc1
    s_add_u32 s44, s39, 8192
    buffer_load_dwordx4 v[128:131], v4, s[8:11], s44 offen offset:0 sc1
    buffer_load_dwordx4 v[132:135], v4, s[8:11], s44 offen offset:1024 sc1
    buffer_load_dwordx4 v[136:139], v4, s[8:11], s44 offen offset:2048 sc1
    buffer_load_dwordx4 v[140:143], v4, s[8:11], s44 offen offset:3072 sc1
k4_h:
    v_lshlrev_b32 v11, 2, v3
    v_sub_u32 v11, v2, v11
    v_cmp_eq_u32 vcc, 0, v11
    s_nop 1
    v_cndmask_b32_e64 v88, 0, 1.0, vcc
    v_lshrrev_b32 v84, 16, v88
    v_cmp_eq_u32 vcc, 1, v11
    s_nop 1
    v_cndmask_b32_e64 v89, 0, 1.0, vcc
    v_lshrrev_b32 v85, 16, v89
    v_cmp_eq_u32 vcc, 2, v11
    s_nop 1
    v_cndmask_b32_e64 v90, 0, 1.0, vcc
    v_lshrrev_b32 v86, 16, v90
    v_cmp_eq_u32 vcc, 3, v11
    s_nop 1
    v_cndmask_b32_e64 v91, 0, 1.0, vcc
    v_lshrrev_b32 v87, 16, v91
    v_lshrrev_b32 v11, 2, v2
    v_cmp_eq_u32 vcc, 0, v11
    s_nop 1
    v_cndmask_b32_e64 v92, 0, 1.0, vcc
    v_cmp_eq_u32 vcc, 1, v11
    s_nop 1
    v_cndmask_b32_e64 v93, 0, 1.0, vcc
    v_cmp_eq_u32 vcc, 2, v11
    s_nop 1
    v_cndmask_b32_e64 v94, 0, 1.0, vcc
    v_cmp_eq_u32 vcc, 3, v11
    s_nop 1
    v_cndmask_b32_e64 v95, 0, 1.0, vcc
    s_mov_b32 s45, 65536
L29:
    s_load_dwordx4 s[48:51], s[8:9], s46 offset:0 glc
    s_waitcnt lgkmcnt(0)
    s_xor_b64 s[48:49], s[48:49], s[100:101]
    s_xor_b64 s[50:51], s[50:51], s[100:101]
    s_or_b64 s[48:49], s[48:49], s[50:51]
    s_cbranch_scc0 L30
    s_sub_u32 s45, s45, 1
    s_cbranch_scc1 L30
    s_sleep 3
    s_branch L29
L30:
    s_add_u32 s44, s4, 1
    s_and_b32 s44, s44, 3
    s_mul_i32 s44, s44, 1179648
    s_add_u32 s44, s44, s38
    s_add_u32 s44, s44, 9437184
    buffer_load_dwordx4 v[144:147], v4, s[8:11], s44 offen sc1
    s_add_u32 s44, s4, 2
    s_and_b32 s44, s44, 3
    s_mul_i32 s44, s44, 1179648
    s_add_u32 s44, s44, s38
    s_add_u32 s44, s44, 9437184
    buffer_load_dwordx4 v[148:151], v4, s[8:11], s44 offen sc1
    s_add_u32 s44, s4, 3
    s_and_b32 s44, s44, 3
    s_mul_i32 s44, s44, 1179648
    s_add_u32 s44, s44, s38
    s_add_u32 s44, s44, 9437184
    buffer_load_dwordx4 v[152:155], v4, s[8:11], s44 offen sc1
    s_add_u32 s44, s4, 1
    s_and_b32 s44, s44, 3
    s_mul_i32 s44, s44, 1179648
    s_add_u32 s44, s44, s38
    s_add_u32 s44, s44, 9449472
    buffer_load_dwordx4 v[156:159], v4, s[8:11], s44 offen sc1
    s_add_u32 s44, s4, 2
    s_and_b32 s44, s44, 3
    s_mul_i32 s44, s44, 1179648
    s_add_u32 s44, s44, s38
    s_add_u32 s44, s44, 9449472
    buffer_load_dwordx4 v[160:163], v4, s[8:11], s44 offen sc1
    s_add_u32 s44, s4, 3
    s_and_b32 s44, s44, 3
    s_mul_i32 s44, s44, 1179648
    s_add_u32 s44, s44, s38
    s_add_u32 s44, s44, 9449472
    buffer_load_dwordx4 v[164:167], v4, s[8:11], s44 offen sc1
    v_mfma_f32_16x16x32_bf16 v[68:71], v[84:87], v[12:15], v[68:71]
    v_mfma_f32_16x16x32_bf16 v[76:79], v[88:91], v[12:15], v[76:79]
    s_waitcnt vmcnt(5)
    v_mfma_f32_16x16x32_bf16 v[68:71], v[84:87], v[144:147], v[68:71]
    v_mfma_f32_16x16x32_bf16 v[76:79], v[88:91], v[144:147], v[76:79]
    s_waitcnt vmcnt(4)
    v_mfma_f32_16x16x32_bf16 v[68:71], v[84:87], v[148:151], v[68:71]
    v_mfma_f32_16x16x32_bf16 v[76:79], v[88:91], v[148:151], v[76:79]
    s_waitcnt vmcnt(3)
    v_mfma_f32_16x16x32_bf16 v[68:71], v[84:87], v[152:155], v[68:71]
    v_mfma_f32_16x16x32_bf16 v[76:79], v[88:91], v[152:155], v[76:79]
    v_mfma_f32_16x16x32_bf16 v[72:75], v[84:87], v[16:19], v[72:75]
    v_mfma_f32_16x16x32_bf16 v[80:83], v[88:91], v[16:19], v[80:83]
    s_waitcnt vmcnt(2)
    v_mfma_f32_16x16x32_bf16 v[72:75], v[84:87], v[156:159], v[72:75]
    v_mfma_f32_16x16x32_bf16 v[80:83], v[88:91], v[156:159], v[80:83]
    s_waitcnt vmcnt(1)
    v_mfma_f32_16x16x32_bf16 v[72:75], v[84:87], v[160:163], v[72:75]
    v_mfma_f32_16x16x32_bf16 v[80:83], v[88:91], v[160:163], v[80:83]
    s_waitcnt vmcnt(0)
    v_mfma_f32_16x16x32_bf16 v[72:75], v[84:87], v[164:167], v[72:75]
    v_mfma_f32_16x16x32_bf16 v[80:83], v[88:91], v[164:167], v[80:83]
    v_cvt_pk_bf16_f32 v12, v68, v76
    v_cvt_pk_bf16_f32 v13, v69, v77
    v_cvt_pk_bf16_f32 v14, v70, v78
    v_cvt_pk_bf16_f32 v15, v71, v79
    s_nop 1
    v_mfma_f32_16x16x32_bf16 v[68:71], v[84:87], v[12:15], 0
    v_mfma_f32_16x16x32_bf16 v[76:79], v[88:91], v[12:15], 0
    v_cvt_pk_bf16_f32 v16, v72, v80
    v_cvt_pk_bf16_f32 v17, v73, v81
    v_cvt_pk_bf16_f32 v18, v74, v82
    v_cvt_pk_bf16_f32 v19, v75, v83
    s_nop 1
    v_mfma_f32_16x16x32_bf16 v[72:75], v[84:87], v[16:19], 0
    v_mfma_f32_16x16x32_bf16 v[80:83], v[88:91], v[16:19], 0
    v_pk_add_f32 v[144:145], v[68:69], v[70:71]
    v_pk_mul_f32 v[146:147], v[68:69], v[68:69]
    v_pk_add_f32 v[144:145], v[144:145], v[76:77]
    v_pk_fma_f32 v[146:147], v[70:71], v[70:71], v[146:147]
    v_pk_add_f32 v[144:145], v[144:145], v[78:79]
    v_pk_fma_f32 v[146:147], v[76:77], v[76:77], v[146:147]
    v_pk_fma_f32 v[146:147], v[78:79], v[78:79], v[146:147]
    v_add_f32 v156, v144, v145
    v_add_f32 v157, v146, v147
    v_pk_add_f32 v[144:145], v[72:73], v[74:75]
    v_pk_mul_f32 v[146:147], v[72:73], v[72:73]
    v_pk_add_f32 v[144:145], v[144:145], v[80:81]
    v_pk_fma_f32 v[146:147], v[74:75], v[74:75], v[146:147]
    v_pk_add_f32 v[144:145], v[144:145], v[82:83]
    v_pk_fma_f32 v[146:147], v[80:81], v[80:81], v[146:147]
    v_pk_fma_f32 v[146:147], v[82:83], v[82:83], v[146:147]
    v_add_f32 v158, v144, v145
    v_add_f32 v159, v146, v147
    v_mfma_f32_16x16x4_f32 v[148:151], v92, v156, 0
    v_mfma_f32_16x16x4_f32 v[148:151], v93, v157, v[148:151]
    v_mfma_f32_16x16x4_f32 v[148:151], v94, v158, v[148:151]
    v_mfma_f32_16x16x4_f32 v[148:151], v95, v159, v[148:151]
    v_and_b32 v10, 3, v2
    v_cmp_eq_u32 vcc, v10, v3
    s_nop 1
    v_cndmask_b32_e64 v10, 0, 1.0, vcc
    s_nop 6
    ds_write_b32 v6, v148 offset:24576
    s_waitcnt lgkmcnt(0)
    s_barrier
    ds_read_b128 v[144:147], v7 offset:24576
    ds_read_b128 v[148:151], v7 offset:24592
    ds_read_b128 v[152:155], v7 offset:24608
    s_cmp_ge_u32 s3, 6
    s_cbranch_scc1 k4_i
    s_add_u32 s44, s39, 12288
    buffer_load_dwordx4 v[20:23], v4, s[8:11], s44 offen offset:0 sc1
    buffer_load_dwordx4 v[24:27], v4, s[8:11], s44 offen offset:1024 sc1
    buffer_load_dwordx4 v[28:31], v4, s[8:11], s44 offen offset:2048 sc1
    buffer_load_dwordx4 v[32:35], v4, s[8:11], s44 offen offset:3072 sc1
    s_add_u32 s44, s39, 16384
    buffer_load_dwordx4 v[36:39], v4, s[8:11], s44 offen offset:0 sc1
    buffer_load_dwordx4 v[40:43], v4, s[8:11], s44 offen offset:1024 sc1
    buffer_load_dwordx4 v[44:47], v4, s[8:11], s44 offen offset:2048 sc1
    buffer_load_dwordx4 v[48:51], v4, s[8:11], s44 offen offset:3072 sc1
    s_add_u32 s44, s39, 20480
    buffer_load_dwordx4 v[52:55], v4, s[8:11], s44 offen offset:0 sc1
    buffer_load_dwordx4 v[56:59], v4, s[8:11], s44 offen offset:1024 sc1
    buffer_load_dwordx4 v[60:63], v4, s[8:11], s44 offen offset:2048 sc1
    buffer_load_dwordx4 v[64:67], v4, s[8:11], s44 offen offset:3072 sc1
k4_i:
    s_waitcnt lgkmcnt(0)
    v_pk_add_f32 v[144:145], v[144:145], v[148:149]
    v_pk_add_f32 v[146:147], v[146:147], v[150:151]
    v_pk_add_f32 v[144:145], v[144:145], v[152:153]
    v_pk_add_f32 v[146:147], v[146:147], v[154:155]
    v_pk_add_f32 v[144:145], v[144:145], v[146:147]
    v_add_f32 v144, v144, v145
    s_nop 1
    v_mfma_f32_16x16x4_f32 v[156:159], v10, v144, 0
    s_nop 11
    v_mul_f32 v156, 0x3b2aaaab, v156
    v_mul_f32 v157, 0x3b2aaaab, v157
    v_fma_f32 v157, -v156, v156, v157
    v_max_f32 v157, 0, v157
    v_add_f32 v157, 0x3727c5ac, v157
    v_rsq_f32 v157, v157
    s_nop 0
    v_mul_f32 v156, -v156, v157
    v_mul_f32 v158, 0x3b2aaaab, v158
    v_mul_f32 v159, 0x3b2aaaab, v159
    v_fma_f32 v159, -v158, v158, v159
    v_max_f32 v159, 0, v159
    v_add_f32 v159, 0x3727c5ac, v159
    v_rsq_f32 v159, v159
    s_nop 0
    v_mul_f32 v158, -v158, v159
    v_pk_fma_f32 v[68:69], v[68:69], v[156:157], v[156:157] op_sel:[0,1,0] op_sel_hi:[1,1,0]
    v_pk_fma_f32 v[70:71], v[70:71], v[156:157], v[156:157] op_sel:[0,1,0] op_sel_hi:[1,1,0]
    v_pk_fma_f32 v[76:77], v[76:77], v[156:157], v[156:157] op_sel:[0,1,0] op_sel_hi:[1,1,0]
    v_pk_fma_f32 v[78:79], v[78:79], v[156:157], v[156:157] op_sel:[0,1,0] op_sel_hi:[1,1,0]
    v_cvt_pk_bf16_f32 v144, v68, v76
    v_cvt_pk_bf16_f32 v145, v69, v77
    v_cvt_pk_bf16_f32 v146, v70, v78
    v_cvt_pk_bf16_f32 v147, v71, v79
    ds_write_b128 v5, v[144:147] offset:0
    v_pk_fma_f32 v[72:73], v[72:73], v[158:159], v[158:159] op_sel:[0,1,0] op_sel_hi:[1,1,0]
    v_pk_fma_f32 v[74:75], v[74:75], v[158:159], v[158:159] op_sel:[0,1,0] op_sel_hi:[1,1,0]
    v_pk_fma_f32 v[80:81], v[80:81], v[158:159], v[158:159] op_sel:[0,1,0] op_sel_hi:[1,1,0]
    v_pk_fma_f32 v[82:83], v[82:83], v[158:159], v[158:159] op_sel:[0,1,0] op_sel_hi:[1,1,0]
    v_cvt_pk_bf16_f32 v148, v72, v80
    v_cvt_pk_bf16_f32 v149, v73, v81
    v_cvt_pk_bf16_f32 v150, v74, v82
    v_cvt_pk_bf16_f32 v151, v75, v83
    ds_write_b128 v5, v[148:151] offset:12288
    s_waitcnt lgkmcnt(0)
    s_barrier
    ds_read_b128 v[144:147], v4 offset:0
    ds_read_b128 v[148:151], v4 offset:12288
    ds_read_b128 v[152:155], v4 offset:1024
    ds_read_b128 v[156:159], v4 offset:13312
    s_waitcnt lgkmcnt(2) vmcnt(63)
    v_mfma_f32_16x16x32_bf16 v[68:71], v[96:99], v[144:147], 0
    v_mfma_f32_16x16x32_bf16 v[72:75], v[96:99], v[148:151], 0
    v_mfma_f32_16x16x32_bf16 v[76:79], v[100:103], v[144:147], 0
    v_mfma_f32_16x16x32_bf16 v[80:83], v[100:103], v[148:151], 0
    s_add_u32 s44, s65, 0
    buffer_load_dwordx4 v[96:99], v4, s[8:11], s44 offen offset:0 sc1
    buffer_load_dwordx4 v[100:103], v4, s[8:11], s44 offen offset:1024 sc1
    ds_read_b128 v[144:147], v4 offset:2048
    ds_read_b128 v[148:151], v4 offset:14336
    s_waitcnt lgkmcnt(2) vmcnt(63)
    v_mfma_f32_16x16x32_bf16 v[68:71], v[104:107], v[152:155], v[68:71]
    v_mfma_f32_16x16x32_bf16 v[72:75], v[104:107], v[156:159], v[72:75]
    v_mfma_f32_16x16x32_bf16 v[76:79], v[108:111], v[152:155], v[76:79]
    v_mfma_f32_16x16x32_bf16 v[80:83], v[108:111], v[156:159], v[80:83]
    s_add_u32 s44, s65, 0
    buffer_load_dwordx4 v[104:107], v4, s[8:11], s44 offen offset:2048 sc1
    buffer_load_dwordx4 v[108:111], v4, s[8:11], s44 offen offset:3072 sc1
    ds_read_b128 v[152:155], v4 offset:3072
    ds_read_b128 v[156:159], v4 offset:15360
    s_waitcnt lgkmcnt(2) vmcnt(63)
    v_mfma_f32_16x16x32_bf16 v[68:71], v[112:115], v[144:147], v[68:71]
    v_mfma_f32_16x16x32_bf16 v[72:75], v[112:115], v[148:151], v[72:75]
    v_mfma_f32_16x16x32_bf16 v[76:79], v[116:119], v[144:147], v[76:79]
    v_mfma_f32_16x16x32_bf16 v[80:83], v[116:119], v[148:151], v[80:83]
    s_add_u32 s44, s65, 4096
    buffer_load_dwordx4 v[112:115], v4, s[8:11], s44 offen offset:0 sc1
    buffer_load_dwordx4 v[116:119], v4, s[8:11], s44 offen offset:1024 sc1
    ds_read_b128 v[144:147], v4 offset:4096
    ds_read_b128 v[148:151], v4 offset:16384
    s_waitcnt lgkmcnt(2) vmcnt(63)
    v_mfma_f32_16x16x32_bf16 v[68:71], v[120:123], v[152:155], v[68:71]
    v_mfma_f32_16x16x32_bf16 v[72:75], v[120:123], v[156:159], v[72:75]
    v_mfma_f32_16x16x32_bf16 v[76:79], v[124:127], v[152:155], v[76:79]
    v_mfma_f32_16x16x32_bf16 v[80:83], v[124:127], v[156:159], v[80:83]
    s_add_u32 s44, s65, 4096
    buffer_load_dwordx4 v[120:123], v4, s[8:11], s44 offen offset:2048 sc1
    buffer_load_dwordx4 v[124:127], v4, s[8:11], s44 offen offset:3072 sc1
    ds_read_b128 v[152:155], v4 offset:5120
    ds_read_b128 v[156:159], v4 offset:17408
    s_waitcnt lgkmcnt(2) vmcnt(63)
    v_mfma_f32_16x16x32_bf16 v[68:71], v[128:131], v[144:147], v[68:71]
    v_mfma_f32_16x16x32_bf16 v[72:75], v[128:131], v[148:151], v[72:75]
    v_mfma_f32_16x16x32_bf16 v[76:79], v[132:135], v[144:147], v[76:79]
    v_mfma_f32_16x16x32_bf16 v[80:83], v[132:135], v[148:151], v[80:83]
    ds_read_b128 v[144:147], v4 offset:6144
    ds_read_b128 v[148:151], v4 offset:18432
    s_waitcnt lgkmcnt(2) vmcnt(63)
    v_mfma_f32_16x16x32_bf16 v[68:71], v[136:139], v[152:155], v[68:71]
    v_mfma_f32_16x16x32_bf16 v[72:75], v[136:139], v[156:159], v[72:75]
    v_mfma_f32_16x16x32_bf16 v[76:79], v[140:143], v[152:155], v[76:79]
    v_mfma_f32_16x16x32_bf16 v[80:83], v[140:143], v[156:159], v[80:83]
    ds_read_b128 v[152:155], v4 offset:7168
    ds_read_b128 v[156:159], v4 offset:19456
    s_waitcnt lgkmcnt(2) vmcnt(18)
    v_mfma_f32_16x16x32_bf16 v[68:71], v[20:23], v[144:147], v[68:71]
    v_mfma_f32_16x16x32_bf16 v[72:75], v[20:23], v[148:151], v[72:75]
    v_mfma_f32_16x16x32_bf16 v[76:79], v[24:27], v[144:147], v[76:79]
    v_mfma_f32_16x16x32_bf16 v[80:83], v[24:27], v[148:151], v[80:83]
    ds_read_b128 v[144:147], v4 offset:8192
    ds_read_b128 v[148:151], v4 offset:20480
    s_waitcnt lgkmcnt(2) vmcnt(16)
    v_mfma_f32_16x16x32_bf16 v[68:71], v[28:31], v[152:155], v[68:71]
    v_mfma_f32_16x16x32_bf16 v[72:75], v[28:31], v[156:159], v[72:75]
    v_mfma_f32_16x16x32_bf16 v[76:79], v[32:35], v[152:155], v[76:79]
    v_mfma_f32_16x16x32_bf16 v[80:83], v[32:35], v[156:159], v[80:83]
    ds_read_b128 v[152:155], v4 offset:9216
    ds_read_b128 v[156:159], v4 offset:21504
    s_waitcnt lgkmcnt(2) vmcnt(14)
    v_mfma_f32_16x16x32_bf16 v[68:71], v[36:39], v[144:147], v[68:71]
    v_mfma_f32_16x16x32_bf16 v[72:75], v[36:39], v[148:151], v[72:75]
    v_mfma_f32_16x16x32_bf16 v[76:79], v[40:43], v[144:147], v[76:79]
    v_mfma_f32_16x16x32_bf16 v[80:83], v[40:43], v[148:151], v[80:83]
    ds_read_b128 v[144:147], v4 offset:10240
    ds_read_b128 v[148:151], v4 offset:22528
    s_waitcnt lgkmcnt(2) vmcnt(12)
    v_mfma_f32_16x16x32_bf16 v[68:71], v[44:47], v[152:155], v[68:71]
    v_mfma_f32_16x16x32_bf16 v[72:75], v[44:47], v[156:159], v[72:75]
    v_mfma_f32_16x16x32_bf16 v[76:79], v[48:51], v[152:155], v[76:79]
    v_mfma_f32_16x16x32_bf16 v[80:83], v[48:51], v[156:159], v[80:83]
    ds_read_b128 v[152:155], v4 offset:11264
    ds_read_b128 v[156:159], v4 offset:23552
    s_waitcnt lgkmcnt(2) vmcnt(10)
    v_mfma_f32_16x16x32_bf16 v[68:71], v[52:55], v[144:147], v[68:71]
    v_mfma_f32_16x16x32_bf16 v[72:75], v[52:55], v[148:151], v[72:75]
    v_mfma_f32_16x16x32_bf16 v[76:79], v[56:59], v[144:147], v[76:79]
    v_mfma_f32_16x16x32_bf16 v[80:83], v[56:59], v[148:151], v[80:83]
    s_waitcnt lgkmcnt(0) vmcnt(8)
    v_mfma_f32_16x16x32_bf16 v[68:71], v[60:63], v[152:155], v[68:71]
    v_mfma_f32_16x16x32_bf16 v[72:75], v[60:63], v[156:159], v[72:75]
    v_mfma_f32_16x16x32_bf16 v[76:79], v[64:67], v[152:155], v[76:79]
    v_mfma_f32_16x16x32_bf16 v[80:83], v[64:67], v[156:159], v[80:83]
    s_lshl_b32 s44, s3, 13
    v_add_u32 v11, s44, v4
    v_add_u32 v11, 65536, v11
    ds_read_b128 v[36:39], v11 offset:0
    ds_read_b128 v[40:43], v11 offset:1024
    ds_read_b128 v[44:47], v11 offset:2048
    ds_read_b128 v[48:51], v11 offset:3072
    ds_read_b128 v[52:55], v11 offset:4096
    ds_read_b128 v[56:59], v11 offset:5120
    ds_read_b128 v[60:63], v11 offset:6144
    ds_read_b128 v[64:67], v11 offset:7168
    v_mov_b32 v11, 0xbdd2d3e8
    v_mov_b32 v10, 0xc0135761
    v_pk_mul_f32 v[144:145], v[68:69], v[68:69]
    v_pk_mul_f32 v[146:147], v[70:71], v[70:71]
    v_pk_mul_f32 v[148:149], v[76:77], v[76:77]
    v_pk_mul_f32 v[150:151], v[78:79], v[78:79]
    v_pk_fma_f32 v[144:145], v[144:145], v[10:11], v[10:11] op_sel:[0,1,0] op_sel_hi:[1,1,0]
    v_pk_fma_f32 v[146:147], v[146:147], v[10:11], v[10:11] op_sel:[0,1,0] op_sel_hi:[1,1,0]
    v_pk_fma_f32 v[148:149], v[148:149], v[10:11], v[10:11] op_sel:[0,1,0] op_sel_hi:[1,1,0]
    v_pk_fma_f32 v[150:151], v[150:151], v[10:11], v[10:11] op_sel:[0,1,0] op_sel_hi:[1,1,0]
    v_pk_mul_f32 v[144:145], v[144:145], v[68:69]
    v_pk_mul_f32 v[146:147], v[146:147], v[70:71]
    v_pk_mul_f32 v[148:149], v[148:149], v[76:77]
    v_pk_mul_f32 v[150:151], v[150:151], v[78:79]
    v_exp_f32 v144, v144
    v_exp_f32 v145, v145
    v_exp_f32 v146, v146
    v_exp_f32 v147, v147
    v_exp_f32 v148, v148
    v_exp_f32 v149, v149
    v_exp_f32 v150, v150
    v_exp_f32 v151, v151
    v_pk_add_f32 v[144:145], v[144:145], 1.0 op_sel_hi:[1,0]
    v_pk_add_f32 v[146:147], v[146:147], 1.0 op_sel_hi:[1,0]
    v_pk_add_f32 v[148:149], v[148:149], 1.0 op_sel_hi:[1,0]
    v_pk_add_f32 v[150:151], v[150:151], 1.0 op_sel_hi:[1,0]
    v_rcp_f32 v144, v144
    v_rcp_f32 v145, v145
    v_rcp_f32 v146, v146
    v_rcp_f32 v147, v147
    v_rcp_f32 v148, v148
    v_rcp_f32 v149, v149
    v_rcp_f32 v150, v150
    v_rcp_f32 v151, v151
    v_pk_mul_f32 v[144:145], v[144:145], v[68:69]
    v_pk_mul_f32 v[146:147], v[146:147], v[70:71]
    v_pk_mul_f32 v[148:149], v[148:149], v[76:77]
    v_pk_mul_f32 v[150:151], v[150:151], v[78:79]
    v_cvt_pk_bf16_f32 v144, v144, v145
    v_cvt_pk_bf16_f32 v145, v146, v147
    v_cvt_pk_bf16_f32 v146, v148, v149
    v_cvt_pk_bf16_f32 v147, v150, v151
    ds_write_b128 v5, v[144:147] offset:40960
    v_pk_mul_f32 v[152:153], v[72:73], v[72:73]
    v_pk_mul_f32 v[154:155], v[74:75], v[74:75]
    v_pk_mul_f32 v[156:157], v[80:81], v[80:81]
    v_pk_mul_f32 v[158:159], v[82:83], v[82:83]
    v_pk_fma_f32 v[152:153], v[152:153], v[10:11], v[10:11] op_sel:[0,1,0] op_sel_hi:[1,1,0]
    v_pk_fma_f32 v[154:155], v[154:155], v[10:11], v[10:11] op_sel:[0,1,0] op_sel_hi:[1,1,0]
    v_pk_fma_f32 v[156:157], v[156:157], v[10:11], v[10:11] op_sel:[0,1,0] op_sel_hi:[1,1,0]
    v_pk_fma_f32 v[158:159], v[158:159], v[10:11], v[10:11] op_sel:[0,1,0] op_sel_hi:[1,1,0]
    v_pk_mul_f32 v[152:153], v[152:153], v[72:73]
    v_pk_mul_f32 v[154:155], v[154:155], v[74:75]
    v_pk_mul_f32 v[156:157], v[156:157], v[80:81]
    v_pk_mul_f32 v[158:159], v[158:159], v[82:83]
    v_exp_f32 v152, v152
    v_exp_f32 v153, v153
    v_exp_f32 v154, v154
    v_exp_f32 v155, v155
    v_exp_f32 v156, v156
    v_exp_f32 v157, v157
    v_exp_f32 v158, v158
    v_exp_f32 v159, v159
    v_pk_add_f32 v[152:153], v[152:153], 1.0 op_sel_hi:[1,0]
    v_pk_add_f32 v[154:155], v[154:155], 1.0 op_sel_hi:[1,0]
    v_pk_add_f32 v[156:157], v[156:157], 1.0 op_sel_hi:[1,0]
    v_pk_add_f32 v[158:159], v[158:159], 1.0 op_sel_hi:[1,0]
    v_rcp_f32 v152, v152
    v_rcp_f32 v153, v153
    v_rcp_f32 v154, v154
    v_rcp_f32 v155, v155
    v_rcp_f32 v156, v156
    v_rcp_f32 v157, v157
    v_rcp_f32 v158, v158
    v_rcp_f32 v159, v159
    v_pk_mul_f32 v[152:153], v[152:153], v[72:73]
    v_pk_mul_f32 v[154:155], v[154:155], v[74:75]
    v_pk_mul_f32 v[156:157], v[156:157], v[80:81]
    v_pk_mul_f32 v[158:159], v[158:159], v[82:83]
    v_cvt_pk_bf16_f32 v152, v152, v153
    v_cvt_pk_bf16_f32 v153, v154, v155
    v_cvt_pk_bf16_f32 v154, v156, v157
    v_cvt_pk_bf16_f32 v155, v158, v159
    ds_write_b128 v5, v[152:155] offset:53248
    s_waitcnt lgkmcnt(0)
    s_barrier
    s_add_u32 s44, s65, 8192
    buffer_load_dwordx4 v[128:131], v4, s[8:11], s44 offen offset:0 sc1
    buffer_load_dwordx4 v[132:135], v4, s[8:11], s44 offen offset:1024 sc1
    ds_read_b128 v[144:147], v4 offset:49152
    ds_read_b128 v[148:151], v4 offset:61440
    ds_read_b128 v[152:155], v4 offset:50176
    ds_read_b128 v[156:159], v4 offset:62464
    s_waitcnt lgkmcnt(2) vmcnt(63)
    v_mfma_f32_16x16x32_bf16 v[68:71], v[36:39], v[144:147], 0
    v_mfma_f32_16x16x32_bf16 v[72:75], v[36:39], v[148:151], 0
    v_mfma_f32_16x16x32_bf16 v[76:79], v[40:43], v[144:147], 0
    v_mfma_f32_16x16x32_bf16 v[80:83], v[40:43], v[148:151], 0
    s_add_u32 s44, s65, 8192
    buffer_load_dwordx4 v[136:139], v4, s[8:11], s44 offen offset:2048 sc1
    buffer_load_dwordx4 v[140:143], v4, s[8:11], s44 offen offset:3072 sc1
    ds_read_b128 v[144:147], v4 offset:51200
    ds_read_b128 v[148:151], v4 offset:63488
    s_waitcnt lgkmcnt(2) vmcnt(63)
    v_mfma_f32_16x16x32_bf16 v[68:71], v[44:47], v[152:155], v[68:71]
    v_mfma_f32_16x16x32_bf16 v[72:75], v[44:47], v[156:159], v[72:75]
    v_mfma_f32_16x16x32_bf16 v[76:79], v[48:51], v[152:155], v[76:79]
    v_mfma_f32_16x16x32_bf16 v[80:83], v[48:51], v[156:159], v[80:83]
    s_add_u32 s44, s65, 12288
    buffer_load_dwordx4 v[20:23], v4, s[8:11], s44 offen offset:0 sc1
    buffer_load_dwordx4 v[24:27], v4, s[8:11], s44 offen offset:1024 sc1
    ds_read_b128 v[152:155], v4 offset:52224
    ds_read_b128 v[156:159], v4 offset:64512
    s_waitcnt lgkmcnt(2) vmcnt(63)
    v_mfma_f32_16x16x32_bf16 v[68:71], v[52:55], v[144:147], v[68:71]
    v_mfma_f32_16x16x32_bf16 v[72:75], v[52:55], v[148:151], v[72:75]
    v_mfma_f32_16x16x32_bf16 v[76:79], v[56:59], v[144:147], v[76:79]
    v_mfma_f32_16x16x32_bf16 v[80:83], v[56:59], v[148:151], v[80:83]
    s_add_u32 s44, s65, 12288
    buffer_load_dwordx4 v[28:31], v4, s[8:11], s44 offen offset:2048 sc1
    buffer_load_dwordx4 v[32:35], v4, s[8:11], s44 offen offset:3072 sc1
    ds_read_b128 v[144:147], v4 offset:40960
    ds_read_b128 v[148:151], v4 offset:53248
    s_waitcnt lgkmcnt(2) vmcnt(63)
    v_mfma_f32_16x16x32_bf16 v[68:71], v[60:63], v[152:155], v[68:71]
    v_mfma_f32_16x16x32_bf16 v[72:75], v[60:63], v[156:159], v[72:75]
    v_mfma_f32_16x16x32_bf16 v[76:79], v[64:67], v[152:155], v[76:79]
    v_mfma_f32_16x16x32_bf16 v[80:83], v[64:67], v[156:159], v[80:83]
    ds_read_b128 v[152:155], v4 offset:41984
    ds_read_b128 v[156:159], v4 offset:54272
    s_waitcnt lgkmcnt(2) vmcnt(14)
    v_mfma_f32_16x16x32_bf16 v[68:71], v[96:99], v[144:147], v[68:71]
    v_mfma_f32_16x16x32_bf16 v[72:75], v[96:99], v[148:151], v[72:75]
    v_mfma_f32_16x16x32_bf16 v[76:79], v[100:103], v[144:147], v[76:79]
    v_mfma_f32_16x16x32_bf16 v[80:83], v[100:103], v[148:151], v[80:83]
    ds_read_b128 v[144:147], v4 offset:43008
    ds_read_b128 v[148:151], v4 offset:55296
    s_waitcnt lgkmcnt(2) vmcnt(12)
    v_mfma_f32_16x16x32_bf16 v[68:71], v[104:107], v[152:155], v[68:71]
    v_mfma_f32_16x16x32_bf16 v[72:75], v[104:107], v[156:159], v[72:75]
    v_mfma_f32_16x16x32_bf16 v[76:79], v[108:111], v[152:155], v[76:79]
    v_mfma_f32_16x16x32_bf16 v[80:83], v[108:111], v[156:159], v[80:83]
    ds_read_b128 v[152:155], v4 offset:44032
    ds_read_b128 v[156:159], v4 offset:56320
    s_waitcnt lgkmcnt(2) vmcnt(10)
    v_mfma_f32_16x16x32_bf16 v[68:71], v[112:115], v[144:147], v[68:71]
    v_mfma_f32_16x16x32_bf16 v[72:75], v[112:115], v[148:151], v[72:75]
    v_mfma_f32_16x16x32_bf16 v[76:79], v[116:119], v[144:147], v[76:79]
    v_mfma_f32_16x16x32_bf16 v[80:83], v[116:119], v[148:151], v[80:83]
    ds_read_b128 v[144:147], v4 offset:45056
    ds_read_b128 v[148:151], v4 offset:57344
    s_waitcnt lgkmcnt(2) vmcnt(8)
    v_mfma_f32_16x16x32_bf16 v[68:71], v[120:123], v[152:155], v[68:71]
    v_mfma_f32_16x16x32_bf16 v[72:75], v[120:123], v[156:159], v[72:75]
    v_mfma_f32_16x16x32_bf16 v[76:79], v[124:127], v[152:155], v[76:79]
    v_mfma_f32_16x16x32_bf16 v[80:83], v[124:127], v[156:159], v[80:83]
    ds_read_b128 v[152:155], v4 offset:46080
    ds_read_b128 v[156:159], v4 offset:58368
    s_waitcnt lgkmcnt(2) vmcnt(6)
    v_mfma_f32_16x16x32_bf16 v[68:71], v[128:131], v[144:147], v[68:71]
    v_mfma_f32_16x16x32_bf16 v[72:75], v[128:131], v[148:151], v[72:75]
    v_mfma_f32_16x16x32_bf16 v[76:79], v[132:135], v[144:147], v[76:79]
    v_mfma_f32_16x16x32_bf16 v[80:83], v[132:135], v[148:151], v[80:83]
    ds_read_b128 v[144:147], v4 offset:47104
    ds_read_b128 v[148:151], v4 offset:59392
    s_waitcnt lgkmcnt(2) vmcnt(4)
    v_mfma_f32_16x16x32_bf16 v[68:71], v[136:139], v[152:155], v[68:71]
    v_mfma_f32_16x16x32_bf16 v[72:75], v[136:139], v[156:159], v[72:75]
    v_mfma_f32_16x16x32_bf16 v[76:79], v[140:143], v[152:155], v[76:79]
    v_mfma_f32_16x16x32_bf16 v[80:83], v[140:143], v[156:159], v[80:83]
    ds_read_b128 v[152:155], v4 offset:48128
    ds_read_b128 v[156:159], v4 offset:60416
    s_waitcnt lgkmcnt(2) vmcnt(2)
    v_mfma_f32_16x16x32_bf16 v[68:71], v[20:23], v[144:147], v[68:71]
    v_mfma_f32_16x16x32_bf16 v[72:75], v[20:23], v[148:151], v[72:75]
    v_mfma_f32_16x16x32_bf16 v[76:79], v[24:27], v[144:147], v[76:79]
    v_mfma_f32_16x16x32_bf16 v[80:83], v[24:27], v[148:151], v[80:83]
    s_waitcnt lgkmcnt(0) vmcnt(0)
    v_mfma_f32_16x16x32_bf16 v[68:71], v[28:31], v[152:155], v[68:71]
    v_mfma_f32_16x16x32_bf16 v[72:75], v[28:31], v[156:159], v[72:75]
    v_mfma_f32_16x16x32_bf16 v[76:79], v[32:35], v[152:155], v[76:79]
    v_mfma_f32_16x16x32_bf16 v[80:83], v[32:35], v[156:159], v[80:83]
    s_add_u32 s46, s37, 29611008
    s_lshl_b32 s47, s4, 2
    s_add_u32 s47, s47, s46
    s_mul_i32 s64, s3, 21846
    s_lshr_b32 s64, s64, 16
    s_cmp_eq_u32 s64, s4
    s_cbranch_scc1 k5_own
    s_add_u32 s44, s36, 15335424
    s_add_u32 s45, s44, 12288
    v_cvt_pk_bf16_f32 v84, v68, v76
    v_cvt_pk_bf16_f32 v85, v69, v77
    v_cvt_pk_bf16_f32 v86, v70, v78
    v_cvt_pk_bf16_f32 v87, v71, v79
    buffer_store_dwordx4 v[84:87], v4, s[8:11], s44 offen sc1
    v_cvt_pk_bf16_f32 v88, v72, v80
    v_cvt_pk_bf16_f32 v89, v73, v81
    v_cvt_pk_bf16_f32 v90, v74, v82
    v_cvt_pk_bf16_f32 v91, v75, v83
    buffer_store_dwordx4 v[88:91], v4, s[8:11], s45 offen sc1
    v_mov_b32 v11, s43
    v_mov_b32 v10, 0
    s_waitcnt vmcnt(0)
    s_mov_b64 exec, 1
    buffer_store_dword v11, v10, s[8:11], s47 offen sc1
    s_mov_b64 exec, -1
    s_endpgm
k5_own:
    s_nop 7
    s_nop 3
    v_mov_b32 v11, s43
    v_mov_b32 v10, 0
    s_waitcnt vmcnt(0)
    s_mov_b64 exec, 1
    buffer_store_dword v11, v10, s[8:11], s47 offen sc1
    s_mov_b64 exec, -1
    s_mov_b32 s45, 65536
L31:
    s_load_dwordx4 s[48:51], s[8:9], s46 offset:0 glc
    s_waitcnt lgkmcnt(0)
    s_xor_b64 s[48:49], s[48:49], s[100:101]
    s_xor_b64 s[50:51], s[50:51], s[100:101]
    s_or_b64 s[48:49], s[48:49], s[50:51]
    s_cbranch_scc0 L32
    s_sub_u32 s45, s45, 1
    s_cbranch_scc1 L32
    s_sleep 3
    s_branch L31
L32:
    s_add_u32 s44, s4, 1
    s_and_b32 s44, s44, 3
    s_mul_i32 s44, s44, 1179648
    s_add_u32 s44, s44, s38
    s_add_u32 s44, s44, 15335424
    buffer_load_dwordx4 v[144:147], v4, s[8:11], s44 offen sc1
    s_add_u32 s44, s4, 2
    s_and_b32 s44, s44, 3
    s_mul_i32 s44, s44, 1179648
    s_add_u32 s44, s44, s38
    s_add_u32 s44, s44, 15335424
    buffer_load_dwordx4 v[148:151], v4, s[8:11], s44 offen sc1
    s_add_u32 s44, s4, 3
    s_and_b32 s44, s44, 3
    s_mul_i32 s44, s44, 1179648
    s_add_u32 s44, s44, s38
    s_add_u32 s44, s44, 15335424
    buffer_load_dwordx4 v[152:155], v4, s[8:11], s44 offen sc1
    s_add_u32 s44, s4, 1
    s_and_b32 s44, s44, 3
    s_mul_i32 s44, s44, 1179648
    s_add_u32 s44, s44, s38
    s_add_u32 s44, s44, 15347712
    buffer_load_dwordx4 v[156:159], v4, s[8:11], s44 offen sc1
    s_add_u32 s44, s4, 2
    s_and_b32 s44, s44, 3
    s_mul_i32 s44, s44, 1179648
    s_add_u32 s44, s44, s38
    s_add_u32 s44, s44, 15347712
    buffer_load_dwordx4 v[160:163], v4, s[8:11], s44 offen sc1
    s_add_u32 s44, s4, 3
    s_and_b32 s44, s44, 3
    s_mul_i32 s44, s44, 1179648
    s_add_u32 s44, s44, s38
    s_add_u32 s44, s44, 15347712
    buffer_load_dwordx4 v[164:167], v4, s[8:11], s44 offen sc1
    v_mfma_f32_16x16x32_bf16 v[68:71], v[84:87], v[12:15], v[68:71]
    v_mfma_f32_16x16x32_bf16 v[76:79], v[88:91], v[12:15], v[76:79]
    s_waitcnt vmcnt(5)
    v_mfma_f32_16x16x32_bf16 v[68:71], v[84:87], v[144:147], v[68:71]
    v_mfma_f32_16x16x32_bf16 v[76:79], v[88:91], v[144:147], v[76:79]
    s_waitcnt vmcnt(4)
    v_mfma_f32_16x16x32_bf16 v[68:71], v[84:87], v[148:151], v[68:71]
    v_mfma_f32_16x16x32_bf16 v[76:79], v[88:91], v[148:151], v[76:79]
    s_waitcnt vmcnt(3)
    v_mfma_f32_16x16x32_bf16 v[68:71], v[84:87], v[152:155], v[68:71]
    v_mfma_f32_16x16x32_bf16 v[76:79], v[88:91], v[152:155], v[76:79]
    v_mfma_f32_16x16x32_bf16 v[72:75], v[84:87], v[16:19], v[72:75]
    v_mfma_f32_16x16x32_bf16 v[80:83], v[88:91], v[16:19], v[80:83]
    s_waitcnt vmcnt(2)
    v_mfma_f32_16x16x32_bf16 v[72:75], v[84:87], v[156:159], v[72:75]
    v_mfma_f32_16x16x32_bf16 v[80:83], v[88:91], v[156:159], v[80:83]
    s_waitcnt vmcnt(1)
    v_mfma_f32_16x16x32_bf16 v[72:75], v[84:87], v[160:163], v[72:75]
    v_mfma_f32_16x16x32_bf16 v[80:83], v[88:91], v[160:163], v[80:83]
    s_waitcnt vmcnt(0)
    v_mfma_f32_16x16x32_bf16 v[72:75], v[84:87], v[164:167], v[72:75]
    v_mfma_f32_16x16x32_bf16 v[80:83], v[88:91], v[164:167], v[80:83]
    v_cvt_pk_bf16_f32 v84, v68, v76
    v_cvt_pk_bf16_f32 v85, v69, v77
    v_cvt_pk_bf16_f32 v86, v70, v78
    v_cvt_pk_bf16_f32 v87, v71, v79
    buffer_store_dwordx4 v[84:87], v0, s[24:27], s33 offen
    s_nop 2
    v_cvt_pk_bf16_f32 v88, v72, v80
    v_cvt_pk_bf16_f32 v89, v73, v81
    v_cvt_pk_bf16_f32 v90, v74, v82
    v_cvt_pk_bf16_f32 v91, v75, v83
    buffer_store_dwordx4 v[88:91], v0, s[24:27], s34 offen
    s_cmp_lg_u32 s2, 56
    s_cbranch_scc1 L33
    s_cmp_lg_u32 s3, 0
    s_cbranch_scc1 L33
    s_mov_b32 s47, 29690880
    v_mov_b32 v11, s43
    v_mov_b32 v10, 0
    s_waitcnt vmcnt(0)
    s_mov_b64 exec, 1
    buffer_store_dword v11, v10, s[8:11], s47 offen sc1
    s_mov_b64 exec, -1
L33:
    s_endpgm
repack:
    s_mul_i32 s4, s2, 12
    s_add_u32 s4, s4, s3
    s_waitcnt lgkmcnt(0)
    s_add_u32 s46, s8, 29690880
    s_addc_u32 s47, s9, 0
    s_load_dword s43, s[46:47], 0
    s_cmp_ge_u32 s4, 648
    s_cbranch_scc1 rp4
    s_cmp_ge_u32 s4, 288
    s_cbranch_scc1 rp2
    s_cmp_ge_u32 s4, 144
    s_cbranch_scc1 rp1
    s_mov_b32 s12, s54
    s_mov_b32 s13, s55
    s_mov_b32 s14, 884736
    s_mov_b32 s15, 0x20000
    s_mul_i32 s5, s4, 5462
    s_lshr_b32 s5, s5, 16
    s_mul_i32 s6, s5, 12
    s_sub_u32 s6, s4, s6
    s_mul_i32 s44, s6, 11
    s_lshr_b32 s44, s44, 5
    s_mul_i32 s44, s44, 72
    s_lshl_b32 s45, s6, 3
    s_add_u32 s44, s44, s45
    s_mul_i32 s44, s44, 2304
    s_mul_i32 s45, s5, 192
    s_add_u32 s44, s44, s45
    v_mul_u32_u24 v10, 55296, v3
    v_mul_u32_u24 v11, 12, v2
    v_add_u32 v10, v10, v11
    buffer_load_dwordx3 v[16:18], v10, s[12:15], s44 offen
    s_add_u32 s44, s44, 2304
    buffer_load_dwordx3 v[20:22], v10, s[12:15], s44 offen
    s_add_u32 s44, s44, 2304
    buffer_load_dwordx3 v[24:26], v10, s[12:15], s44 offen
    s_add_u32 s44, s44, 2304
    buffer_load_dwordx3 v[28:30], v10, s[12:15], s44 offen
    s_add_u32 s44, s44, 2304
    buffer_load_dwordx3 v[32:34], v10, s[12:15], s44 offen
    s_add_u32 s44, s44, 2304
    buffer_load_dwordx3 v[36:38], v10, s[12:15], s44 offen
    s_add_u32 s44, s44, 2304
    buffer_load_dwordx3 v[40:42], v10, s[12:15], s44 offen
    s_add_u32 s44, s44, 2304
    buffer_load_dwordx3 v[44:46], v10, s[12:15], s44 offen
    s_add_u32 s44, s44, 2304
    s_lshl_b32 s47, s5, 7
    s_lshl_b32 s45, s6, 2
    s_add_u32 s47, s47, s45
    s_add_u32 s47, s47, 29684736
    s_and_b32 s28, s5, 3
    s_mul_i32 s28, s28, 6
    s_lshr_b32 s29, s5, 2
    s_mul_i32 s44, s29, 3
    s_add_u32 s44, s44, s28
    s_mul_i32 s44, s44, 24576
    s_lshl_b32 s45, s6, 11
    s_add_u32 s44, s44, s45
    s_mul_i32 s30, s28, 12288
    s_lshl_b32 s45, s6, 10
    s_add_u32 s30, s30, s45
    s_add_u32 s30, s30, 589824
    s_mov_b32 s33, 12288
    s_cmp_eq_u32 s29, 2
    s_cselect_b32 s44, s30, s44
    s_cselect_b32 s30, s33, 1024
    s_cselect_b32 s31, s33, 23552
    s_add_u32 s44, s44, 24772608
    s_waitcnt vmcnt(0) lgkmcnt(0)
    s_add_u32 s43, s43, 1
    v_perm_b32 v48, v20, v16, s40
    v_perm_b32 v49, v28, v24, s40
    v_perm_b32 v50, v36, v32, s40
    v_perm_b32 v51, v44, v40, s40
    v_perm_b32 v52, v20, v16, s41
    v_perm_b32 v53, v28, v24, s41
    v_perm_b32 v54, v36, v32, s41
    v_perm_b32 v55, v44, v40, s41
    v_perm_b32 v56, v21, v17, s40
    v_perm_b32 v57, v29, v25, s40
    v_perm_b32 v58, v37, v33, s40
    v_perm_b32 v59, v45, v41, s40
    v_perm_b32 v60, v21, v17, s41
    v_perm_b32 v61, v29, v25, s41
    v_perm_b32 v62, v37, v33, s41
    v_perm_b32 v63, v45, v41, s41
    v_perm_b32 v64, v22, v18, s40
    v_perm_b32 v65, v30, v26, s40
    v_perm_b32 v66, v38, v34, s40
    v_perm_b32 v67, v46, v42, s40
    v_perm_b32 v68, v22, v18, s41
    v_perm_b32 v69, v30, v26, s41
    v_perm_b32 v70, v38, v34, s41
    v_perm_b32 v71, v46, v42, s41
    buffer_store_dwordx4 v[48:51], v4, s[8:11], s44 offen sc1
    s_add_u32 s44, s44, s30
    buffer_store_dwordx4 v[52:55], v4, s[8:11], s44 offen sc1
    s_add_u32 s44, s44, s31
    buffer_store_dwordx4 v[56:59], v4, s[8:11], s44 offen sc1
    s_add_u32 s44, s44, s30
    buffer_store_dwordx4 v[60:63], v4, s[8:11], s44 offen sc1
    s_add_u32 s44, s44, s31
    buffer_store_dwordx4 v[64:67], v4, s[8:11], s44 offen sc1
    s_add_u32 s44, s44, s30
    buffer_store_dwordx4 v[68:71], v4, s[8:11], s44 offen sc1
    s_add_u32 s44, s44, s31
    v_mov_b32 v11, s43
    v_mov_b32 v10, 0
    s_waitcnt vmcnt(0)
    s_mov_b64 exec, 1
    buffer_store_dword v11, v10, s[8:11], s47 offen sc1
    s_mov_b64 exec, -1
    s_branch pf
rp1:
    s_sub_u32 s4, s4, 144
    s_mov_b32 s12, s58
    s_mov_b32 s13, s59
    s_mov_b32 s14, 1179648
    s_mov_b32 s15, 0x20000
    s_mul_i32 s5, s4, 5462
    s_lshr_b32 s5, s5, 16
    s_mul_i32 s6, s5, 12
    s_sub_u32 s6, s4, s6
    s_mul_i32 s44, s6, 11
    s_lshr_b32 s44, s44, 5
    s_mul_i32 s44, s44, 72
    s_lshl_b32 s45, s6, 3
    s_add_u32 s44, s44, s45
    s_mul_i32 s44, s44, 3072
    s_mul_i32 s45, s5, 256
    s_add_u32 s44, s44, s45
    v_mul_u32_u24 v10, 73728, v3
    v_mul_u32_u24 v11, 16, v2
    v_add_u32 v10, v10, v11
    buffer_load_dwordx4 v[16:19], v10, s[12:15], s44 offen
    s_add_u32 s44, s44, 3072
    buffer_load_dwordx4 v[20:23], v10, s[12:15], s44 offen
    s_add_u32 s44, s44, 3072
    buffer_load_dwordx4 v[24:27], v10, s[12:15], s44 offen
    s_add_u32 s44, s44, 3072
    buffer_load_dwordx4 v[28:31], v10, s[12:15], s44 offen
    s_add_u32 s44, s44, 3072
    buffer_load_dwordx4 v[32:35], v10, s[12:15], s44 offen
    s_add_u32 s44, s44, 3072
    buffer_load_dwordx4 v[36:39], v10, s[12:15], s44 offen
    s_add_u32 s44, s44, 3072
    buffer_load_dwordx4 v[40:43], v10, s[12:15], s44 offen
    s_add_u32 s44, s44, 3072
    buffer_load_dwordx4 v[44:47], v10, s[12:15], s44 offen
    s_add_u32 s44, s44, 3072
    s_lshl_b32 s47, s5, 7
    s_lshl_b32 s45, s6, 2
    s_add_u32 s47, s47, s45
    s_add_u32 s47, s47, 29686272
    s_mul_i32 s44, s5, 98304
    s_lshl_b32 s45, s6, 11
    s_add_u32 s44, s44, s45
    s_add_u32 s44, s44, 25952256
    s_mov_b32 s30, 1024
    s_mov_b32 s31, 23552
    s_waitcnt vmcnt(0) lgkmcnt(0)
    s_add_u32 s43, s43, 1
    v_perm_b32 v48, v20, v16, s40
    v_perm_b32 v49, v28, v24, s40
    v_perm_b32 v50, v36, v32, s40
    v_perm_b32 v51, v44, v40, s40
    v_perm_b32 v52, v20, v16, s41
    v_perm_b32 v53, v28, v24, s41
    v_perm_b32 v54, v36, v32, s41
    v_perm_b32 v55, v44, v40, s41
    v_perm_b32 v56, v21, v17, s40
    v_perm_b32 v57, v29, v25, s40
    v_perm_b32 v58, v37, v33, s40
    v_perm_b32 v59, v45, v41, s40
    v_perm_b32 v60, v21, v17, s41
    v_perm_b32 v61, v29, v25, s41
    v_perm_b32 v62, v37, v33, s41
    v_perm_b32 v63, v45, v41, s41
    v_perm_b32 v64, v22, v18, s40
    v_perm_b32 v65, v30, v26, s40
    v_perm_b32 v66, v38, v34, s40
    v_perm_b32 v67, v46, v42, s40
    v_perm_b32 v68, v22, v18, s41
    v_perm_b32 v69, v30, v26, s41
    v_perm_b32 v70, v38, v34, s41
    v_perm_b32 v71, v46, v42, s41
    v_perm_b32 v72, v23, v19, s40
    v_perm_b32 v73, v31, v27, s40
    v_perm_b32 v74, v39, v35, s40
    v_perm_b32 v75, v47, v43, s40
    v_perm_b32 v76, v23, v19, s41
    v_perm_b32 v77, v31, v27, s41
    v_perm_b32 v78, v39, v35, s41
    v_perm_b32 v79, v47, v43, s41
    buffer_store_dwordx4 v[48:51], v4, s[8:11], s44 offen sc1
    s_add_u32 s44, s44, s30
    buffer_store_dwordx4 v[52:55], v4, s[8:11], s44 offen sc1
    s_add_u32 s44, s44, s31
    buffer_store_dwordx4 v[56:59], v4, s[8:11], s44 offen sc1
    s_add_u32 s44, s44, s30
    buffer_store_dwordx4 v[60:63], v4, s[8:11], s44 offen sc1
    s_add_u32 s44, s44, s31
    buffer_store_dwordx4 v[64:67], v4, s[8:11], s44 offen sc1
    s_add_u32 s44, s44, s30
    buffer_store_dwordx4 v[68:71], v4, s[8:11], s44 offen sc1
    s_add_u32 s44, s44, s31
    buffer_store_dwordx4 v[72:75], v4, s[8:11], s44 offen sc1
    s_add_u32 s44, s44, s30
    buffer_store_dwordx4 v[76:79], v4, s[8:11], s44 offen sc1
    s_add_u32 s44, s44, s31
    v_mov_b32 v11, s43
    v_mov_b32 v10, 0
    s_waitcnt vmcnt(0)
    s_mov_b64 exec, 1
    buffer_store_dword v11, v10, s[8:11], s47 offen sc1
    s_mov_b64 exec, -1
    s_branch pf
rp2:
    s_cmp_ge_u32 s4, 360
    s_cbranch_scc1 rp3
    s_sub_u32 s4, s4, 288
    s_mov_b32 s12, s56
    s_mov_b32 s13, s57
    s_mov_b32 s14, 294912
    s_mov_b32 s15, 0x20000
    s_mul_i32 s6, s4, 5462
    s_lshr_b32 s6, s6, 16
    s_mul_i32 s5, s6, 12
    s_sub_u32 s5, s4, s5
    s_mul_i32 s28, s5, 11
    s_lshr_b32 s28, s28, 5
    s_mul_i32 s28, s28, 144
    s_lshl_b32 s45, s5, 4
    s_add_u32 s28, s28, s45
    v_lshrrev_b32 v10, 2, v2
    v_mul_u32_u24 v10, 48, v10
    v_and_b32 v11, 3, v2
    v_lshl_add_u32 v10, v11, 2, v10
    v_mul_u32_u24 v11, 18432, v3
    v_add3_u32 v10, v10, v11, s28
    s_lshl_b32 s29, s6, 1
    s_add_u32 s29, s29, 0
    s_mul_i32 s30, s29, 21846
    s_lshr_b32 s30, s30, 16
    s_mul_i32 s31, s30, 3
    s_sub_u32 s31, s29, s31
    s_mul_i32 s46, s30, 96
    s_lshl_b32 s45, s31, 1
    s_add_u32 s46, s46, s45
    s_mul_i32 s32, s30, 12
    s_add_u32 s32, s32, s5
    s_mul_i32 s32, s32, 6144
    s_lshl_b32 s45, s31, 11
    s_add_u32 s32, s32, s45
    s_add_u32 s32, s32, 25657344
    s_mul_i32 s46, s46, 768
    s_add_u32 s44, s46, 0
    buffer_load_dword v16, v10, s[12:15], s44 offen
    s_add_u32 s44, s46, 4608
    buffer_load_dword v17, v10, s[12:15], s44 offen
    s_add_u32 s44, s46, 9216
    buffer_load_dword v18, v10, s[12:15], s44 offen
    s_add_u32 s44, s46, 13824
    buffer_load_dword v19, v10, s[12:15], s44 offen
    s_add_u32 s44, s46, 768
    buffer_load_dword v20, v10, s[12:15], s44 offen
    s_add_u32 s44, s46, 5376
    buffer_load_dword v21, v10, s[12:15], s44 offen
    s_add_u32 s44, s46, 9984
    buffer_load_dword v22, v10, s[12:15], s44 offen
    s_add_u32 s44, s46, 14592
    buffer_load_dword v23, v10, s[12:15], s44 offen
    s_lshl_b32 s29, s6, 1
    s_add_u32 s29, s29, 1
    s_mul_i32 s30, s29, 21846
    s_lshr_b32 s30, s30, 16
    s_mul_i32 s31, s30, 3
    s_sub_u32 s31, s29, s31
    s_mul_i32 s46, s30, 96
    s_lshl_b32 s45, s31, 1
    s_add_u32 s46, s46, s45
    s_mul_i32 s33, s30, 12
    s_add_u32 s33, s33, s5
    s_mul_i32 s33, s33, 6144
    s_lshl_b32 s45, s31, 11
    s_add_u32 s33, s33, s45
    s_add_u32 s33, s33, 25657344
    s_mul_i32 s46, s46, 768
    s_add_u32 s44, s46, 0
    buffer_load_dword v24, v10, s[12:15], s44 offen
    s_add_u32 s44, s46, 4608
    buffer_load_dword v25, v10, s[12:15], s44 offen
    s_add_u32 s44, s46, 9216
    buffer_load_dword v26, v10, s[12:15], s44 offen
    s_add_u32 s44, s46, 13824
    buffer_load_dword v27, v10, s[12:15], s44 offen
    s_add_u32 s44, s46, 768
    buffer_load_dword v28, v10, s[12:15], s44 offen
    s_add_u32 s44, s46, 5376
    buffer_load_dword v29, v10, s[12:15], s44 offen
    s_add_u32 s44, s46, 9984
    buffer_load_dword v30, v10, s[12:15], s44 offen
    s_add_u32 s44, s46, 14592
    buffer_load_dword v31, v10, s[12:15], s44 offen
    s_lshl_b32 s47, s5, 7
    s_lshl_b32 s45, s6, 2
    s_add_u32 s47, s47, s45
    s_add_u32 s47, s47, 29687808
    s_waitcnt vmcnt(0) lgkmcnt(0)
    s_add_u32 s43, s43, 1
    v_perm_b32 v32, v17, v16, s40
    v_perm_b32 v33, v19, v18, s40
    v_perm_b32 v34, v21, v20, s40
    v_perm_b32 v35, v23, v22, s40
    v_perm_b32 v36, v17, v16, s41
    v_perm_b32 v37, v19, v18, s41
    v_perm_b32 v38, v21, v20, s41
    v_perm_b32 v39, v23, v22, s41
    buffer_store_dwordx4 v[32:35], v4, s[8:11], s32 offen offset:0 sc1
    buffer_store_dwordx4 v[36:39], v4, s[8:11], s32 offen offset:1024 sc1
    v_perm_b32 v40, v25, v24, s40
    v_perm_b32 v41, v27, v26, s40
    v_perm_b32 v42, v29, v28, s40
    v_perm_b32 v43, v31, v30, s40
    v_perm_b32 v44, v25, v24, s41
    v_perm_b32 v45, v27, v26, s41
    v_perm_b32 v46, v29, v28, s41
    v_perm_b32 v47, v31, v30, s41
    buffer_store_dwordx4 v[40:43], v4, s[8:11], s33 offen offset:0 sc1
    buffer_store_dwordx4 v[44:47], v4, s[8:11], s33 offen offset:1024 sc1
    v_mov_b32 v11, s43
    v_mov_b32 v10, 0
    s_waitcnt vmcnt(0)
    s_mov_b64 exec, 1
    buffer_store_dword v11, v10, s[8:11], s47 offen sc1
    s_mov_b64 exec, -1
    s_branch pf
rp3:
    s_sub_u32 s4, s4, 360
    s_mov_b32 s12, s60
    s_mov_b32 s13, s61
    s_mov_b32 s14, 1179648
    s_mov_b32 s15, 0x20000
    s_mul_i32 s6, s4, 5462
    s_lshr_b32 s6, s6, 16
    s_mul_i32 s5, s6, 12
    s_sub_u32 s5, s4, s5
    s_mul_i32 s28, s5, 11
    s_lshr_b32 s28, s28, 5
    s_mul_i32 s28, s28, 144
    s_lshl_b32 s45, s5, 4
    s_add_u32 s28, s28, s45
    v_lshrrev_b32 v10, 2, v2
    v_mul_u32_u24 v10, 48, v10
    v_and_b32 v11, 3, v2
    v_lshl_add_u32 v10, v11, 2, v10
    v_mul_u32_u24 v11, 24576, v3
    v_add3_u32 v10, v10, v11, s28
    s_lshl_b32 s29, s6, 1
    s_add_u32 s29, s29, 0
    s_mul_i32 s30, s29, 5462
    s_lshr_b32 s30, s30, 16
    s_mul_i32 s31, s30, 12
    s_sub_u32 s31, s29, s31
    s_lshr_b32 s46, s29, 2
    s_lshl_b32 s46, s46, 7
    s_and_b32 s45, s29, 3
    s_lshl_b32 s45, s45, 1
    s_add_u32 s46, s46, s45
    s_mul_i32 s32, s30, 12
    s_add_u32 s32, s32, s5
    s_mul_i32 s32, s32, 24576
    s_lshl_b32 s45, s31, 11
    s_add_u32 s32, s32, s45
    s_add_u32 s32, s32, 27131904
    s_mul_i32 s46, s46, 768
    s_add_u32 s44, s46, 0
    buffer_load_dword v16, v10, s[12:15], s44 offen
    s_add_u32 s44, s46, 6144
    buffer_load_dword v17, v10, s[12:15], s44 offen
    s_add_u32 s44, s46, 12288
    buffer_load_dword v18, v10, s[12:15], s44 offen
    s_add_u32 s44, s46, 18432
    buffer_load_dword v19, v10, s[12:15], s44 offen
    s_add_u32 s44, s46, 768
    buffer_load_dword v20, v10, s[12:15], s44 offen
    s_add_u32 s44, s46, 6912
    buffer_load_dword v21, v10, s[12:15], s44 offen
    s_add_u32 s44, s46, 13056
    buffer_load_dword v22, v10, s[12:15], s44 offen
    s_add_u32 s44, s46, 19200
    buffer_load_dword v23, v10, s[12:15], s44 offen
    s_lshl_b32 s29, s6, 1
    s_add_u32 s29, s29, 1
    s_mul_i32 s30, s29, 5462
    s_lshr_b32 s30, s30, 16
    s_mul_i32 s31, s30, 12
    s_sub_u32 s31, s29, s31
    s_lshr_b32 s46, s29, 2
    s_lshl_b32 s46, s46, 7
    s_and_b32 s45, s29, 3
    s_lshl_b32 s45, s45, 1
    s_add_u32 s46, s46, s45
    s_mul_i32 s33, s30, 12
    s_add_u32 s33, s33, s5
    s_mul_i32 s33, s33, 24576
    s_lshl_b32 s45, s31, 11
    s_add_u32 s33, s33, s45
    s_add_u32 s33, s33, 27131904
    s_mul_i32 s46, s46, 768
    s_add_u32 s44, s46, 0
    buffer_load_dword v24, v10, s[12:15], s44 offen
    s_add_u32 s44, s46, 6144
    buffer_load_dword v25, v10, s[12:15], s44 offen
    s_add_u32 s44, s46, 12288
    buffer_load_dword v26, v10, s[12:15], s44 offen
    s_add_u32 s44, s46, 18432
    buffer_load_dword v27, v10, s[12:15], s44 offen
    s_add_u32 s44, s46, 768
    buffer_load_dword v28, v10, s[12:15], s44 offen
    s_add_u32 s44, s46, 6912
    buffer_load_dword v29, v10, s[12:15], s44 offen
    s_add_u32 s44, s46, 13056
    buffer_load_dword v30, v10, s[12:15], s44 offen
    s_add_u32 s44, s46, 19200
    buffer_load_dword v31, v10, s[12:15], s44 offen
    s_lshl_b32 s47, s5, 7
    s_lshl_b32 s45, s6, 2
    s_add_u32 s47, s47, s45
    s_add_u32 s47, s47, 29689344
    s_waitcnt vmcnt(0) lgkmcnt(0)
    s_add_u32 s43, s43, 1
    v_perm_b32 v32, v17, v16, s40
    v_perm_b32 v33, v19, v18, s40
    v_perm_b32 v34, v21, v20, s40
    v_perm_b32 v35, v23, v22, s40
    v_perm_b32 v36, v17, v16, s41
    v_perm_b32 v37, v19, v18, s41
    v_perm_b32 v38, v21, v20, s41
    v_perm_b32 v39, v23, v22, s41
    buffer_store_dwordx4 v[32:35], v4, s[8:11], s32 offen offset:0 sc1
    buffer_store_dwordx4 v[36:39], v4, s[8:11], s32 offen offset:1024 sc1
    v_perm_b32 v40, v25, v24, s40
    v_perm_b32 v41, v27, v26, s40
    v_perm_b32 v42, v29, v28, s40
    v_perm_b32 v43, v31, v30, s40
    v_perm_b32 v44, v25, v24, s41
    v_perm_b32 v45, v27, v26, s41
    v_perm_b32 v46, v29, v28, s41
    v_perm_b32 v47, v31, v30, s41
    buffer_store_dwordx4 v[40:43], v4, s[8:11], s33 offen offset:0 sc1
    buffer_store_dwordx4 v[44:47], v4, s[8:11], s33 offen offset:1024 sc1
    v_mov_b32 v11, s43
    v_mov_b32 v10, 0
    s_waitcnt vmcnt(0)
    s_mov_b64 exec, 1
    buffer_store_dword v11, v10, s[8:11], s47 offen sc1
    s_mov_b64 exec, -1
    s_branch pf
rp4:
    s_waitcnt lgkmcnt(0)
    s_add_u32 s43, s43, 1
pf:
    s_nop 7
    s_nop 3
    s_lshr_b32 s4, s2, 3
    s_mul_i32 s5, s3, 7
    s_add_u32 s4, s4, s5
    v_mul_u32_u24 v4, 128, v1
    s_mov_b32 s7, 48
    s_cmp_ge_u32 s4, 48
    s_cbranch_scc1 pf_n
pf_l:
    s_mul_i32 s5, s4, 10923
    s_lshr_b32 s5, s5, 16
    s_mul_i32 s6, s5, 6
    s_sub_u32 s6, s4, s6
    s_cmp_ge_u32 s6, 3
    s_cselect_b32 s6, 4, 0
    s_add_u32 s46, s5, s6
    s_mul_i32 s5, s4, 21846
    s_lshr_b32 s5, s5, 16
    s_cmp_ge_u32 s4, 24
    s_cselect_b32 s46, s5, s46
    s_cselect_b32 s30, 30, 12
    s_lshl_b32 s46, s46, 7
    s_add_u32 s46, s46, 29684736
    s_mov_b32 s28, 0
    s_mov_b32 s29, 11
    s_cmp_lt_u32 s4, 36
    s_cbranch_scc1 pf_go
    s_mul_i32 s5, s5, 3
    s_sub_u32 s5, s4, s5
    s_lshl_b32 s46, s5, 9
    s_add_u32 s46, s46, 29687808
    s_mov_b32 s28, 128
    s_mov_b32 s29, 5
    s_mov_b32 s30, 42
    s_cmp_lt_u32 s4, 48
    s_cbranch_scc1 pf_go
    s_lshr_b32 s46, s4, 2
    s_lshl_b32 s46, s46, 7
    s_add_u32 s46, s46, 29684736
    s_mov_b32 s28, 0
    s_mov_b32 s29, 11
    s_mov_b32 s30, 72
    s_cmp_lt_u32 s4, 96
    s_cbranch_scc1 pf_go
    s_mul_i32 s5, s4, 5462
    s_lshr_b32 s5, s5, 16
    s_mul_i32 s6, s5, 12
    s_sub_u32 s6, s4, s6
    s_lshl_b32 s46, s6, 7
    s_mul_i32 s5, s5, 24
    s_add_u32 s46, s46, s5
    s_add_u32 s46, s46, 29689152
    s_mov_b32 s29, 5
    s_mov_b32 s30, 120
pf_go:
    s_cmp_ge_u32 s4, s30
    s_cselect_b32 s30, 1, 0
    s_and_b32 s31, s2, 1
    s_cmp_lg_u32 s30, s31
    s_cbranch_scc1 pf_n
    v_min_u32 v10, s29, v2
    v_lshl_add_u32 v10, v10, 2, s46
    v_mad_u32_u24 v10, v3, s28, v10
    s_mov_b32 s45, 1024
L34:
    buffer_load_dword v11, v10, s[8:11], 0 offen sc1
    s_waitcnt vmcnt(0)
    v_cmp_ne_u32 vcc, s43, v11
    s_nop 1
    s_cbranch_vccz L35
    s_sub_u32 s45, s45, 1
    s_cbranch_scc1 the_end
    s_sleep 1
    s_branch L34
L35:
    s_mul_i32 s44, s4, 24576
    s_add_u32 s44, s44, 24772608
    buffer_load_dword v16, v4, s[8:11], s44 offen sc1
    s_add_u32 s44, s44, 8192
    s_waitcnt vmcnt(0)
    buffer_load_dword v17, v4, s[8:11], s44 offen sc1
    s_add_u32 s44, s44, 8192
    s_waitcnt vmcnt(0)
    buffer_load_dword v18, v4, s[8:11], s44 offen sc1
    s_add_u32 s44, s44, 8192
    s_waitcnt vmcnt(0)
pf_n:
    s_cmp_ge_u32 s3, 2
    s_cbranch_scc1 the_end
    s_add_u32 s4, s4, s7
    s_mov_b32 s7, 14
    s_cmp_lt_u32 s4, 144
    s_cbranch_scc1 pf_l
    s_waitcnt vmcnt(0)
    s_endpgm
the_end:
    s_endpgm
.section .rodata,"a"
.p2align 6
.amdhsa_kernel standalone__video_videomae__vision_kernel
  .amdhsa_next_free_vgpr 168
  .amdhsa_next_free_sgpr 102
  .amdhsa_accum_offset 168
  .amdhsa_group_segment_fixed_size 0
  .amdhsa_kernarg_size 80
  .amdhsa_user_sgpr_count 2
  .amdhsa_user_sgpr_kernarg_segment_ptr 1
  .amdhsa_system_sgpr_workgroup_id_x 1
.end_amdhsa_kernel
```
